```python
import torch

def _softmax(x, axis=-1):
    return torch.softmax(x, dim=axis)
def _gelu(x):
    return torch.nn.functional.gelu(x, approximate="tanh")
def _silu(x):
    return torch.nn.functional.silu(x)
def _sigmoid(x):
    return torch.sigmoid(x)
def _layernorm(x, axis=-1, eps=1e-5):
    m = x.mean(dim=axis, keepdim=True)
    v = x.var(dim=axis, keepdim=True, unbiased=False)
    return (x - m) / torch.sqrt(v + eps)
def _scatter_add(tgt, idx, src, axis=0):
    return tgt.clone().index_add_(axis, idx, src)
def _segment_sum(src, seg, n):
    out = torch.zeros((n,) + src.shape[1:], dtype=src.dtype)
    return out.index_add_(0, seg, src)
def _pad(x, pw):
    flat = tuple(v for pair in reversed(pw) for v in pair)
    return torch.nn.functional.pad(x, flat)

kernel_name = 'standalone__mixer_token_mlp__prompt'

def setup_inputs():

    _w = (lambda a: (lambda t: t.to(torch.bfloat16) if t.is_floating_point() else t)(torch.as_tensor(a)))
    B, S, D, F = 1, 2048, 1024, 3584
    return {
        "x": _w((lambda *s: torch.randn(*s, dtype=torch.bfloat16) * 0.05)(B, S, D)),
        "w1": _w((lambda *s: torch.randn(*s, dtype=torch.bfloat16) * 0.2)(S, F) * (S ** -0.5)),
        "b1": _w((lambda *s: torch.randn(*s, dtype=torch.bfloat16) * 1.6)(F) * 0.02),
        "w2": _w((lambda *s: torch.randn(*s, dtype=torch.bfloat16) * 0.05)(F, S) * (F ** -0.5)),
        "b2": _w((lambda *s: torch.randn(*s, dtype=torch.bfloat16) * 0.1)(S) * 0.02),
    }

def reference(x, w1, b1, w2, b2):
    B, S, D = x.shape
    h = _layernorm(x, axis=-1)
    u = torch.einsum("bsd,sf->bdf", h, w1) + b1
    u = _gelu(u)
    y = torch.einsum("bdf,fs->bds", u, w2) + b2
    return (lambda x, *d: x.permute(*d))(y, 0, 2, 1)
```

```asm
; @launch grid=(256,1,1) block=(512,1,1) lds=131328
.amdgcn_target "amdgcn-amd-amdhsa--gfx950"
.text
.globl standalone__mixer_token_mlp__prompt_kernel
.p2align 8
.type standalone__mixer_token_mlp__prompt_kernel,@function
standalone__mixer_token_mlp__prompt_kernel:
    s_cmp_ge_u32 s2, 256
    s_cbranch_scc1 L_end
    s_load_dwordx16 s[4:19], s[0:1], 0
    v_readfirstlane_b32 s3, v0
    s_nop 0
    s_lshr_b32 s3, s3, 6
    s_cmp_ge_u32 s3, 4
    s_cbranch_scc1 L_loader
    s_lshr_b32 s48, s2, 2
    s_and_b32 s49, s2, 3
    s_lshl_b32 s50, s48, 5
    s_lshl_b32 s51, s49, 2
    s_add_u32 s50, s50, s51
    s_lshl_b32 s50, s50, 11
    v_lshlrev_b32 v1, 3, v0
    s_waitcnt lgkmcnt(0)
    s_add_u32 s36, s18, 20971520
    s_addc_u32 s37, s19, 0
    s_mov_b32 s38, 655360
    s_mov_b32 s39, 0x20000
    s_load_dword s20, s[36:37], 0
    s_and_b32 s21, s2, 7
    s_lshr_b32 s22, s2, 3
    s_mul_i32 s66, s22, 37
    s_lshr_b32 s66, s66, 8
    s_mul_i32 s67, s66, 7
    s_sub_u32 s69, s22, s67
    s_and_b32 s67, s21, 3
    s_mul_i32 s23, s67, 7
    s_add_u32 s23, s23, s69
    s_and_b32 s26, s21, 4
    s_add_u32 s24, s26, s66
    s_and_b32 s27, s22, 1
    s_lshl_b32 s25, s67, 2
    s_bfe_u32 s66, s22, 0x20001
    s_add_u32 s25, s25, s66
    s_lshr_b32 s66, s22, 3
    s_add_u32 s26, s26, s66
    s_lshr_b32 s63, s3, 1
    s_lshl_b32 s63, s63, 7
    v_bfe_u32 v19, v0, 4, 2
    v_lshlrev_b32 v19, 3, v19
    s_lshl_b32 s61, s25, 8
    s_add_u32 s61, s61, s63
    s_lshl_b32 s62, s27, 6
    s_add_u32 s61, s61, s62
    s_lshl_b32 s68, s23, 8
    s_add_u32 s68, s68, s63
    s_min_u32 s68, s68, 7040
    s_add_u32 s50, s8, s68
    s_addc_u32 s51, s9, 0
    s_add_u32 s60, s12, s61
    s_addc_u32 s61, s13, 0
    s_load_dwordx16 s[72:87], s[50:51], 0
    s_load_dwordx8 s[88:95], s[50:51], 64
    s_load_dwordx8 s[28:35], s[50:51], 96
    s_load_dwordx8 s[52:59], s[60:61], 0
    s_load_dwordx4 s[96:99], s[60:61], 32
    s_load_dwordx4 s[40:43], s[60:61], 48
    s_mov_b32 s44, s18
    s_mov_b32 s45, s19
    s_mov_b32 s46, 4259840
    s_mov_b32 s47, 0x20000
    v_lshrrev_b32 v62, 5, v0
    v_mul_u32_u24 v62, 532480, v62
    v_bfe_u32 v63, v0, 4, 1
    v_lshlrev_b32 v63, 12, v63
    v_add_u32 v62, v62, v63
    v_and_b32 v63, 15, v0
    v_lshlrev_b32 v63, 4, v63
    v_add_u32 v62, v62, v63
    s_lshl_b32 s48, s48, 13
    s_lshl_b32 s49, s49, 8
    s_add_u32 s48, s48, s49
    v_mov_b32 v64, 131072
    s_waitcnt lgkmcnt(0)
    s_mul_i32 s20, s20, 0x9e3779b1
    s_add_u32 s20, s20, 0x7f4a7c15
    v_mov_b32 v104, s72
    v_mov_b32 v105, s73
    v_mov_b32 v106, s80
    v_mov_b32 v107, s81
    v_mov_b32 v108, s88
    v_mov_b32 v109, s89
    v_mov_b32 v110, s28
    v_mov_b32 v111, s29
    v_mov_b32 v192, s52
    v_mov_b32 v193, s53
    v_mov_b32 v194, s96
    v_mov_b32 v195, s97
    s_mov_b32 exec_lo, 4294901760
    s_mov_b32 exec_hi, -1
    v_mov_b32 v104, s74
    v_mov_b32 v105, s75
    v_mov_b32 v106, s82
    v_mov_b32 v107, s83
    v_mov_b32 v108, s90
    v_mov_b32 v109, s91
    v_mov_b32 v110, s30
    v_mov_b32 v111, s31
    v_mov_b32 v192, s54
    v_mov_b32 v193, s55
    v_mov_b32 v194, s98
    v_mov_b32 v195, s99
    s_mov_b32 exec_lo, 0
    s_mov_b32 exec_hi, -1
    v_mov_b32 v104, s76
    v_mov_b32 v105, s77
    v_mov_b32 v106, s84
    v_mov_b32 v107, s85
    v_mov_b32 v108, s92
    v_mov_b32 v109, s93
    v_mov_b32 v110, s32
    v_mov_b32 v111, s33
    v_mov_b32 v192, s56
    v_mov_b32 v193, s57
    v_mov_b32 v194, s40
    v_mov_b32 v195, s41
    s_mov_b32 exec_lo, 0
    s_mov_b32 exec_hi, 4294901760
    v_mov_b32 v104, s78
    v_mov_b32 v105, s79
    v_mov_b32 v106, s86
    v_mov_b32 v107, s87
    v_mov_b32 v108, s94
    v_mov_b32 v109, s95
    v_mov_b32 v110, s34
    v_mov_b32 v111, s35
    v_mov_b32 v192, s58
    v_mov_b32 v193, s59
    v_mov_b32 v194, s42
    v_mov_b32 v195, s43
    s_mov_b64 exec, -1
    s_barrier
    ds_read_b64 v[2:3], v1 offset:16384
    ds_read_b64 v[4:5], v1 offset:18432
    ds_read_b64 v[6:7], v1 offset:20480
    ds_read_b64 v[8:9], v1 offset:22528
    ds_read_b64 v[10:11], v1 offset:24576
    ds_read_b64 v[12:13], v1 offset:26624
    ds_read_b64 v[14:15], v1 offset:28672
    ds_read_b64 v[16:17], v1 offset:30720
    ds_read_b128 v[20:23], v64 offset:0
    ds_read_b128 v[24:27], v64 offset:16
    ds_read_b128 v[28:31], v64 offset:32
    ds_read_b128 v[32:35], v64 offset:48
    s_waitcnt lgkmcnt(11)
    v_lshlrev_b32 v70, 16, v2
    v_and_b32 v71, 0xffff0000, v2
    v_lshlrev_b32 v72, 16, v3
    v_and_b32 v73, 0xffff0000, v3
    s_waitcnt lgkmcnt(10)
    v_lshlrev_b32 v74, 16, v4
    v_and_b32 v75, 0xffff0000, v4
    v_lshlrev_b32 v76, 16, v5
    v_and_b32 v77, 0xffff0000, v5
    s_waitcnt lgkmcnt(9)
    v_lshlrev_b32 v78, 16, v6
    v_and_b32 v79, 0xffff0000, v6
    v_lshlrev_b32 v80, 16, v7
    v_and_b32 v81, 0xffff0000, v7
    s_waitcnt lgkmcnt(8)
    v_lshlrev_b32 v82, 16, v8
    v_and_b32 v83, 0xffff0000, v8
    v_lshlrev_b32 v84, 16, v9
    v_and_b32 v85, 0xffff0000, v9
    s_waitcnt lgkmcnt(7)
    v_lshlrev_b32 v86, 16, v10
    v_and_b32 v87, 0xffff0000, v10
    v_lshlrev_b32 v88, 16, v11
    v_and_b32 v89, 0xffff0000, v11
    s_waitcnt lgkmcnt(6)
    v_lshlrev_b32 v90, 16, v12
    v_and_b32 v91, 0xffff0000, v12
    v_lshlrev_b32 v92, 16, v13
    v_and_b32 v93, 0xffff0000, v13
    s_waitcnt lgkmcnt(5)
    v_lshlrev_b32 v94, 16, v14
    v_and_b32 v95, 0xffff0000, v14
    v_lshlrev_b32 v96, 16, v15
    v_and_b32 v97, 0xffff0000, v15
    s_waitcnt lgkmcnt(4)
    v_lshlrev_b32 v98, 16, v16
    v_and_b32 v99, 0xffff0000, v16
    v_lshlrev_b32 v100, 16, v17
    v_and_b32 v101, 0xffff0000, v17
    s_waitcnt lgkmcnt(3)
    v_pk_fma_f32 v[70:71], v[70:71], v[20:21], v[20:21] op_sel:[0,0,1] op_sel_hi:[1,0,1]
    v_pk_fma_f32 v[74:75], v[74:75], v[22:23], v[22:23] op_sel:[0,0,1] op_sel_hi:[1,0,1]
    s_waitcnt lgkmcnt(2)
    v_pk_fma_f32 v[78:79], v[78:79], v[24:25], v[24:25] op_sel:[0,0,1] op_sel_hi:[1,0,1]
    v_pk_fma_f32 v[82:83], v[82:83], v[26:27], v[26:27] op_sel:[0,0,1] op_sel_hi:[1,0,1]
    s_waitcnt lgkmcnt(1)
    v_pk_fma_f32 v[86:87], v[86:87], v[28:29], v[28:29] op_sel:[0,0,1] op_sel_hi:[1,0,1]
    v_pk_fma_f32 v[90:91], v[90:91], v[30:31], v[30:31] op_sel:[0,0,1] op_sel_hi:[1,0,1]
    s_waitcnt lgkmcnt(0)
    v_pk_fma_f32 v[94:95], v[94:95], v[32:33], v[32:33] op_sel:[0,0,1] op_sel_hi:[1,0,1]
    v_pk_fma_f32 v[98:99], v[98:99], v[34:35], v[34:35] op_sel:[0,0,1] op_sel_hi:[1,0,1]
    v_cvt_pk_bf16_f32 v44, v70, v74
    v_cvt_pk_bf16_f32 v45, v78, v82
    v_cvt_pk_bf16_f32 v46, v86, v90
    v_cvt_pk_bf16_f32 v47, v94, v98
    buffer_store_dwordx4 v[44:47], v62, s[44:47], s48 offen offset:0 sc1
    v_cvt_pk_bf16_f32 v48, v71, v75
    v_cvt_pk_bf16_f32 v49, v79, v83
    v_cvt_pk_bf16_f32 v50, v87, v91
    v_cvt_pk_bf16_f32 v51, v95, v99
    buffer_store_dwordx4 v[48:51], v62, s[44:47], s48 offen offset:1024 sc1
    v_pk_fma_f32 v[72:73], v[72:73], v[20:21], v[20:21] op_sel:[0,0,1] op_sel_hi:[1,0,1]
    v_pk_fma_f32 v[76:77], v[76:77], v[22:23], v[22:23] op_sel:[0,0,1] op_sel_hi:[1,0,1]
    v_pk_fma_f32 v[80:81], v[80:81], v[24:25], v[24:25] op_sel:[0,0,1] op_sel_hi:[1,0,1]
    v_pk_fma_f32 v[84:85], v[84:85], v[26:27], v[26:27] op_sel:[0,0,1] op_sel_hi:[1,0,1]
    v_pk_fma_f32 v[88:89], v[88:89], v[28:29], v[28:29] op_sel:[0,0,1] op_sel_hi:[1,0,1]
    v_pk_fma_f32 v[92:93], v[92:93], v[30:31], v[30:31] op_sel:[0,0,1] op_sel_hi:[1,0,1]
    v_pk_fma_f32 v[96:97], v[96:97], v[32:33], v[32:33] op_sel:[0,0,1] op_sel_hi:[1,0,1]
    v_pk_fma_f32 v[100:101], v[100:101], v[34:35], v[34:35] op_sel:[0,0,1] op_sel_hi:[1,0,1]
    v_cvt_pk_bf16_f32 v52, v72, v76
    v_cvt_pk_bf16_f32 v53, v80, v84
    v_cvt_pk_bf16_f32 v54, v88, v92
    v_cvt_pk_bf16_f32 v55, v96, v100
    buffer_store_dwordx4 v[52:55], v62, s[44:47], s48 offen offset:2048 sc1
    v_cvt_pk_bf16_f32 v56, v73, v77
    v_cvt_pk_bf16_f32 v57, v81, v85
    v_cvt_pk_bf16_f32 v58, v89, v93
    v_cvt_pk_bf16_f32 v59, v97, v101
    buffer_store_dwordx4 v[56:59], v62, s[44:47], s48 offen offset:3072 sc1
    s_lshr_b32 s48, s2, 3
    s_lshl_b32 s48, s48, 7
    s_and_b32 s49, s2, 7
    s_lshl_b32 s49, s49, 2
    s_add_u32 s48, s48, s49
    s_lshl_b32 s49, s3, 13
    s_add_u32 s48, s48, s49
    s_add_u32 s48, s48, 65536
    v_and_b32 v2, 63, v0
    v_lshlrev_b32 v3, 12, v2
    v_mov_b32 v4, s20
    s_barrier
    s_waitcnt vmcnt(0)
    s_mov_b64 exec, 3
    buffer_store_dword v4, v3, s[36:39], s48 offen sc1
    s_mov_b64 exec, -1
    s_barrier
    s_and_b32 s62, s3, 1
    s_lshr_b32 s63, s3, 1
    s_lshl_b32 s54, s2, 10
    s_lshl_b32 s55, s3, 8
    s_add_u32 s54, s54, s55
    s_add_u32 s54, s54, 393216
    s_xor_b32 s55, s54, 0x2000
    s_getreg_b32 s64, hwreg(HW_REG_XCC_ID, 0, 4)
    s_add_u32 s64, s64, 1
    s_add_u32 s64, s64, s20
    v_mov_b32 v6, s64
    v_mov_b32 v7, 128
    s_mov_b64 exec, 1
    buffer_store_dword v6, v7, s[36:39], s54 offen sc1
    s_mov_b64 exec, -1
    s_cmp_ge_u32 s2, 224
    s_cbranch_scc1 L_c_g2
    v_lshrrev_b32 v3, 4, v2
    v_and_b32 v4, 15, v2
    v_lshrrev_b32 v6, 2, v4
    v_lshl_add_u32 v7, v3, 2, v6
    v_and_b32 v18, 7, v7
    v_lshlrev_b32 v7, 8, v7
    v_and_b32 v19, 3, v4
    v_lshl_add_u32 v7, v19, 3, v7
    s_lshl_b32 s50, s63, 2
    s_xor_b32 s51, s50, 0
    v_xor_b32 v19, s51, v18
    v_lshl_add_u32 v8, v19, 5, v7
    v_add_u32 v12, 0x10000, v8
    s_xor_b32 s51, s50, 1
    v_xor_b32 v19, s51, v18
    v_lshl_add_u32 v9, v19, 5, v7
    v_add_u32 v13, 0x10000, v9
    s_xor_b32 s51, s50, 2
    v_xor_b32 v19, s51, v18
    v_lshl_add_u32 v10, v19, 5, v7
    v_add_u32 v14, 0x10000, v10
    s_xor_b32 s51, s50, 3
    v_xor_b32 v19, s51, v18
    v_lshl_add_u32 v11, v19, 5, v7
    v_add_u32 v15, 0x10000, v11
    s_lshl_b32 s50, s62, 12
    v_lshl_add_u32 v16, v2, 4, s50
    v_add_u32 v17, 0x10000, v16
    v_lshlrev_b32 v32, 16, v104
    v_mul_f32 v32, 0x3eeff558, v32
    v_mov_b32 v36, v32
    v_mov_b32 v40, v32
    v_mov_b32 v44, v32
    v_and_b32 v33, 0xffff0000, v104
    v_mul_f32 v33, 0x3eeff558, v33
    v_mov_b32 v37, v33
    v_mov_b32 v41, v33
    v_mov_b32 v45, v33
    v_lshlrev_b32 v34, 16, v105
    v_mul_f32 v34, 0x3eeff558, v34
    v_mov_b32 v38, v34
    v_mov_b32 v42, v34
    v_mov_b32 v46, v34
    v_and_b32 v35, 0xffff0000, v105
    v_mul_f32 v35, 0x3eeff558, v35
    v_mov_b32 v39, v35
    v_mov_b32 v43, v35
    v_mov_b32 v47, v35
    v_lshlrev_b32 v48, 16, v106
    v_mul_f32 v48, 0x3eeff558, v48
    v_mov_b32 v52, v48
    v_mov_b32 v56, v48
    v_mov_b32 v60, v48
    v_and_b32 v49, 0xffff0000, v106
    v_mul_f32 v49, 0x3eeff558, v49
    v_mov_b32 v53, v49
    v_mov_b32 v57, v49
    v_mov_b32 v61, v49
    v_lshlrev_b32 v50, 16, v107
    v_mul_f32 v50, 0x3eeff558, v50
    v_mov_b32 v54, v50
    v_mov_b32 v58, v50
    v_mov_b32 v62, v50
    v_and_b32 v51, 0xffff0000, v107
    v_mul_f32 v51, 0x3eeff558, v51
    v_mov_b32 v55, v51
    v_mov_b32 v59, v51
    v_mov_b32 v63, v51
    v_lshlrev_b32 v64, 16, v108
    v_mul_f32 v64, 0x3eeff558, v64
    v_mov_b32 v68, v64
    v_mov_b32 v72, v64
    v_mov_b32 v76, v64
    v_and_b32 v65, 0xffff0000, v108
    v_mul_f32 v65, 0x3eeff558, v65
    v_mov_b32 v69, v65
    v_mov_b32 v73, v65
    v_mov_b32 v77, v65
    v_lshlrev_b32 v66, 16, v109
    v_mul_f32 v66, 0x3eeff558, v66
    v_mov_b32 v70, v66
    v_mov_b32 v74, v66
    v_mov_b32 v78, v66
    v_and_b32 v67, 0xffff0000, v109
    v_mul_f32 v67, 0x3eeff558, v67
    v_mov_b32 v71, v67
    v_mov_b32 v75, v67
    v_mov_b32 v79, v67
    v_lshlrev_b32 v80, 16, v110
    v_mul_f32 v80, 0x3eeff558, v80
    v_mov_b32 v84, v80
    v_mov_b32 v88, v80
    v_mov_b32 v92, v80
    v_and_b32 v81, 0xffff0000, v110
    v_mul_f32 v81, 0x3eeff558, v81
    v_mov_b32 v85, v81
    v_mov_b32 v89, v81
    v_mov_b32 v93, v81
    v_lshlrev_b32 v82, 16, v111
    v_mul_f32 v82, 0x3eeff558, v82
    v_mov_b32 v86, v82
    v_mov_b32 v90, v82
    v_mov_b32 v94, v82
    v_and_b32 v83, 0xffff0000, v111
    v_mul_f32 v83, 0x3eeff558, v83
    v_mov_b32 v87, v83
    v_mov_b32 v91, v83
    v_mov_b32 v95, v83
    s_add_u32 s44, s18, 6291456
    s_addc_u32 s45, s19, 0
    s_mov_b32 s46, 7405568
    s_mov_b32 s47, 0x20000
    s_cmp_ge_u32 s23, 14
    s_cselect_b32 s52, 1, 0
    s_cselect_b32 s53, 14, 0
    s_sub_u32 s53, s23, s53
    s_mul_i32 s48, s52, 56
    s_lshl_b32 s49, s53, 1
    s_add_u32 s48, s48, s49
    s_add_u32 s48, s48, s63
    s_lshl_b32 s48, s48, 13
    s_mul_i32 s49, s24, 925696
    s_add_u32 s48, s48, s49
    s_lshl_b32 s49, s62, 12
    s_add_u32 s48, s48, s49
    s_add_u32 s49, s48, 229376
    v_lshlrev_b32 v4, 4, v2
    v_mov_b32 v22, 0x409d30fc
    v_mov_b32 v23, v22
    v_mov_b32 v24, 0x3eeff558
    v_mov_b32 v25, v24
    s_lshl_b32 s53, s53, 7
    s_lshl_b32 s50, s24, 1
    s_add_u32 s52, s52, s50
    s_lshl_b32 s52, s52, 12
    s_add_u32 s52, s52, s53
    s_lshl_b32 s53, s3, 2
    s_add_u32 s52, s52, s53
    s_add_u32 s52, s52, 131072
    s_add_u32 s53, s52, 2048
    v_mov_b32 v20, 0
    v_mov_b32 v21, s20
    s_mov_b32 s68, 1
    s_mov_b32 s65, 8
    s_mov_b32 s69, 255
    s_barrier
L_c_main:
    s_barrier
    v_mov_b32 v5, 128
    s_cmp_eq_u32 s68, 1
    s_cbranch_scc1 L_c_noid
    buffer_load_dword v30, v5, s[36:39], s55 offen sc1
    s_branch L_c_go
L_c_noid:
L_c_go:
    ds_read_b64_tr_b16 v[96:97], v8 offset:0
    ds_read_b64_tr_b16 v[98:99], v8 offset:4096
    ds_read_b64_tr_b16 v[100:101], v8 offset:8192
    ds_read_b64_tr_b16 v[102:103], v8 offset:12288
    ds_read_b128 v[128:131], v16 offset:16384
    ds_read_b128 v[144:147], v16 offset:24576
    ds_read_b128 v[132:135], v16 offset:17408
    ds_read_b128 v[148:151], v16 offset:25600
    ds_read_b128 v[136:139], v16 offset:18432
    ds_read_b128 v[152:155], v16 offset:26624
    ds_read_b128 v[140:143], v16 offset:19456
    ds_read_b128 v[156:159], v16 offset:27648
.p2align 6
L_c_loop:
    s_waitcnt lgkmcnt(0)
    v_mfma_f32_16x16x32_bf16 v[32:35], v[96:99], v[128:131], v[32:35]
    ds_read_b64_tr_b16 v[104:105], v9 offset:0
    v_mfma_f32_16x16x32_bf16 v[32:35], v[100:103], v[144:147], v[32:35]
    ds_read_b64_tr_b16 v[106:107], v9 offset:4096
    v_mfma_f32_16x16x32_bf16 v[36:39], v[100:103], v[148:151], v[36:39]
    ds_read_b64_tr_b16 v[108:109], v9 offset:8192
    v_mfma_f32_16x16x32_bf16 v[36:39], v[96:99], v[132:135], v[36:39]
    ds_read_b64_tr_b16 v[110:111], v9 offset:12288
    v_mfma_f32_16x16x32_bf16 v[40:43], v[96:99], v[136:139], v[40:43]
    ds_read_b64_tr_b16 v[112:113], v10 offset:0
    v_mfma_f32_16x16x32_bf16 v[40:43], v[100:103], v[152:155], v[40:43]
    ds_read_b64_tr_b16 v[114:115], v10 offset:4096
    v_mfma_f32_16x16x32_bf16 v[44:47], v[100:103], v[156:159], v[44:47]
    ds_read_b64_tr_b16 v[116:117], v10 offset:8192
    v_mfma_f32_16x16x32_bf16 v[44:47], v[96:99], v[140:143], v[44:47]
    ds_read_b64_tr_b16 v[118:119], v10 offset:12288
    s_waitcnt lgkmcnt(4)
    v_mfma_f32_16x16x32_bf16 v[60:63], v[104:107], v[140:143], v[60:63]
    ds_read_b64_tr_b16 v[120:121], v11 offset:0
    v_mfma_f32_16x16x32_bf16 v[60:63], v[108:111], v[156:159], v[60:63]
    ds_read_b64_tr_b16 v[122:123], v11 offset:4096
    v_mfma_f32_16x16x32_bf16 v[56:59], v[108:111], v[152:155], v[56:59]
    ds_read_b64_tr_b16 v[124:125], v11 offset:8192
    v_mfma_f32_16x16x32_bf16 v[56:59], v[104:107], v[136:139], v[56:59]
    ds_read_b64_tr_b16 v[126:127], v11 offset:12288
    v_mfma_f32_16x16x32_bf16 v[52:55], v[104:107], v[132:135], v[52:55]
    v_mfma_f32_16x16x32_bf16 v[52:55], v[108:111], v[148:151], v[52:55]
    v_mfma_f32_16x16x32_bf16 v[48:51], v[108:111], v[144:147], v[48:51]
    v_mfma_f32_16x16x32_bf16 v[48:51], v[104:107], v[128:131], v[48:51]
    s_waitcnt lgkmcnt(0)
    s_barrier
    v_mfma_f32_16x16x32_bf16 v[64:67], v[112:115], v[128:131], v[64:67]
    ds_read_b64_tr_b16 v[96:97], v8 offset:32768
    v_mfma_f32_16x16x32_bf16 v[64:67], v[116:119], v[144:147], v[64:67]
    ds_read_b64_tr_b16 v[98:99], v8 offset:36864
    v_mfma_f32_16x16x32_bf16 v[68:71], v[116:119], v[148:151], v[68:71]
    ds_read_b64_tr_b16 v[100:101], v8 offset:40960
    v_mfma_f32_16x16x32_bf16 v[68:71], v[112:115], v[132:135], v[68:71]
    ds_read_b64_tr_b16 v[102:103], v8 offset:45056
    v_mfma_f32_16x16x32_bf16 v[72:75], v[112:115], v[136:139], v[72:75]
    ds_read_b128 v[160:163], v16 offset:49152
    v_mfma_f32_16x16x32_bf16 v[72:75], v[116:119], v[152:155], v[72:75]
    ds_read_b128 v[176:179], v16 offset:57344
    v_mfma_f32_16x16x32_bf16 v[76:79], v[116:119], v[156:159], v[76:79]
    ds_read_b128 v[164:167], v16 offset:50176
    v_mfma_f32_16x16x32_bf16 v[76:79], v[112:115], v[140:143], v[76:79]
    ds_read_b128 v[180:183], v16 offset:58368
    v_mfma_f32_16x16x32_bf16 v[92:95], v[120:123], v[140:143], v[92:95]
    ds_read_b128 v[168:171], v16 offset:51200
    v_mfma_f32_16x16x32_bf16 v[92:95], v[124:127], v[156:159], v[92:95]
    ds_read_b128 v[184:187], v16 offset:59392
    v_mfma_f32_16x16x32_bf16 v[88:91], v[124:127], v[152:155], v[88:91]
    ds_read_b128 v[172:175], v16 offset:52224
    v_mfma_f32_16x16x32_bf16 v[88:91], v[120:123], v[136:139], v[88:91]
    ds_read_b128 v[188:191], v16 offset:60416
    v_mfma_f32_16x16x32_bf16 v[84:87], v[120:123], v[132:135], v[84:87]
    v_mfma_f32_16x16x32_bf16 v[84:87], v[124:127], v[148:151], v[84:87]
    v_mfma_f32_16x16x32_bf16 v[80:83], v[124:127], v[144:147], v[80:83]
    v_mfma_f32_16x16x32_bf16 v[80:83], v[120:123], v[128:131], v[80:83]
    s_waitcnt lgkmcnt(0)
    v_mfma_f32_16x16x32_bf16 v[32:35], v[96:99], v[160:163], v[32:35]
    ds_read_b64_tr_b16 v[104:105], v9 offset:32768
    v_mfma_f32_16x16x32_bf16 v[32:35], v[100:103], v[176:179], v[32:35]
    ds_read_b64_tr_b16 v[106:107], v9 offset:36864
    v_mfma_f32_16x16x32_bf16 v[36:39], v[100:103], v[180:183], v[36:39]
    ds_read_b64_tr_b16 v[108:109], v9 offset:40960
    v_mfma_f32_16x16x32_bf16 v[36:39], v[96:99], v[164:167], v[36:39]
    ds_read_b64_tr_b16 v[110:111], v9 offset:45056
    v_mfma_f32_16x16x32_bf16 v[40:43], v[96:99], v[168:171], v[40:43]
    ds_read_b64_tr_b16 v[112:113], v10 offset:32768
    v_mfma_f32_16x16x32_bf16 v[40:43], v[100:103], v[184:187], v[40:43]
    ds_read_b64_tr_b16 v[114:115], v10 offset:36864
    v_mfma_f32_16x16x32_bf16 v[44:47], v[100:103], v[188:191], v[44:47]
    ds_read_b64_tr_b16 v[116:117], v10 offset:40960
    v_mfma_f32_16x16x32_bf16 v[44:47], v[96:99], v[172:175], v[44:47]
    ds_read_b64_tr_b16 v[118:119], v10 offset:45056
    s_waitcnt lgkmcnt(4)
    v_mfma_f32_16x16x32_bf16 v[60:63], v[104:107], v[172:175], v[60:63]
    ds_read_b64_tr_b16 v[120:121], v11 offset:32768
    v_mfma_f32_16x16x32_bf16 v[60:63], v[108:111], v[188:191], v[60:63]
    ds_read_b64_tr_b16 v[122:123], v11 offset:36864
    v_mfma_f32_16x16x32_bf16 v[56:59], v[108:111], v[184:187], v[56:59]
    ds_read_b64_tr_b16 v[124:125], v11 offset:40960
    v_mfma_f32_16x16x32_bf16 v[56:59], v[104:107], v[168:171], v[56:59]
    ds_read_b64_tr_b16 v[126:127], v11 offset:45056
    v_mfma_f32_16x16x32_bf16 v[52:55], v[104:107], v[164:167], v[52:55]
    v_mfma_f32_16x16x32_bf16 v[52:55], v[108:111], v[180:183], v[52:55]
    v_mfma_f32_16x16x32_bf16 v[48:51], v[108:111], v[176:179], v[48:51]
    v_mfma_f32_16x16x32_bf16 v[48:51], v[104:107], v[160:163], v[48:51]
    s_waitcnt lgkmcnt(0)
    s_barrier
    v_mfma_f32_16x16x32_bf16 v[64:67], v[112:115], v[160:163], v[64:67]
    ds_read_b64_tr_b16 v[96:97], v12 offset:0
    v_mfma_f32_16x16x32_bf16 v[64:67], v[116:119], v[176:179], v[64:67]
    ds_read_b64_tr_b16 v[98:99], v12 offset:4096
    v_mfma_f32_16x16x32_bf16 v[68:71], v[116:119], v[180:183], v[68:71]
    ds_read_b64_tr_b16 v[100:101], v12 offset:8192
    v_mfma_f32_16x16x32_bf16 v[68:71], v[112:115], v[164:167], v[68:71]
    ds_read_b64_tr_b16 v[102:103], v12 offset:12288
    v_mfma_f32_16x16x32_bf16 v[72:75], v[112:115], v[168:171], v[72:75]
    ds_read_b128 v[128:131], v17 offset:16384
    v_mfma_f32_16x16x32_bf16 v[72:75], v[116:119], v[184:187], v[72:75]
    ds_read_b128 v[144:147], v17 offset:24576
    v_mfma_f32_16x16x32_bf16 v[76:79], v[116:119], v[188:191], v[76:79]
    ds_read_b128 v[132:135], v17 offset:17408
    v_mfma_f32_16x16x32_bf16 v[76:79], v[112:115], v[172:175], v[76:79]
    ds_read_b128 v[148:151], v17 offset:25600
    v_mfma_f32_16x16x32_bf16 v[92:95], v[120:123], v[172:175], v[92:95]
    ds_read_b128 v[136:139], v17 offset:18432
    v_mfma_f32_16x16x32_bf16 v[92:95], v[124:127], v[188:191], v[92:95]
    ds_read_b128 v[152:155], v17 offset:26624
    v_mfma_f32_16x16x32_bf16 v[88:91], v[124:127], v[184:187], v[88:91]
    ds_read_b128 v[140:143], v17 offset:19456
    v_mfma_f32_16x16x32_bf16 v[88:91], v[120:123], v[168:171], v[88:91]
    ds_read_b128 v[156:159], v17 offset:27648
    v_mfma_f32_16x16x32_bf16 v[84:87], v[120:123], v[164:167], v[84:87]
    v_mfma_f32_16x16x32_bf16 v[84:87], v[124:127], v[180:183], v[84:87]
    v_mfma_f32_16x16x32_bf16 v[80:83], v[124:127], v[176:179], v[80:83]
    v_mfma_f32_16x16x32_bf16 v[80:83], v[120:123], v[160:163], v[80:83]
    s_waitcnt lgkmcnt(0)
    v_mfma_f32_16x16x32_bf16 v[32:35], v[96:99], v[128:131], v[32:35]
    ds_read_b64_tr_b16 v[104:105], v13 offset:0
    v_mfma_f32_16x16x32_bf16 v[32:35], v[100:103], v[144:147], v[32:35]
    ds_read_b64_tr_b16 v[106:107], v13 offset:4096
    v_mfma_f32_16x16x32_bf16 v[36:39], v[100:103], v[148:151], v[36:39]
    ds_read_b64_tr_b16 v[108:109], v13 offset:8192
    v_mfma_f32_16x16x32_bf16 v[36:39], v[96:99], v[132:135], v[36:39]
    ds_read_b64_tr_b16 v[110:111], v13 offset:12288
    v_mfma_f32_16x16x32_bf16 v[40:43], v[96:99], v[136:139], v[40:43]
    ds_read_b64_tr_b16 v[112:113], v14 offset:0
    v_mfma_f32_16x16x32_bf16 v[40:43], v[100:103], v[152:155], v[40:43]
    ds_read_b64_tr_b16 v[114:115], v14 offset:4096
    v_mfma_f32_16x16x32_bf16 v[44:47], v[100:103], v[156:159], v[44:47]
    ds_read_b64_tr_b16 v[116:117], v14 offset:8192
    v_mfma_f32_16x16x32_bf16 v[44:47], v[96:99], v[140:143], v[44:47]
    ds_read_b64_tr_b16 v[118:119], v14 offset:12288
    s_waitcnt lgkmcnt(4)
    v_mfma_f32_16x16x32_bf16 v[60:63], v[104:107], v[140:143], v[60:63]
    ds_read_b64_tr_b16 v[120:121], v15 offset:0
    v_mfma_f32_16x16x32_bf16 v[60:63], v[108:111], v[156:159], v[60:63]
    ds_read_b64_tr_b16 v[122:123], v15 offset:4096
    v_mfma_f32_16x16x32_bf16 v[56:59], v[108:111], v[152:155], v[56:59]
    ds_read_b64_tr_b16 v[124:125], v15 offset:8192
    v_mfma_f32_16x16x32_bf16 v[56:59], v[104:107], v[136:139], v[56:59]
    ds_read_b64_tr_b16 v[126:127], v15 offset:12288
    v_mfma_f32_16x16x32_bf16 v[52:55], v[104:107], v[132:135], v[52:55]
    v_mfma_f32_16x16x32_bf16 v[52:55], v[108:111], v[148:151], v[52:55]
    v_mfma_f32_16x16x32_bf16 v[48:51], v[108:111], v[144:147], v[48:51]
    v_mfma_f32_16x16x32_bf16 v[48:51], v[104:107], v[128:131], v[48:51]
    s_waitcnt lgkmcnt(0)
    s_barrier
    v_mfma_f32_16x16x32_bf16 v[64:67], v[112:115], v[128:131], v[64:67]
    ds_read_b64_tr_b16 v[96:97], v12 offset:32768
    v_mfma_f32_16x16x32_bf16 v[64:67], v[116:119], v[144:147], v[64:67]
    ds_read_b64_tr_b16 v[98:99], v12 offset:36864
    v_mfma_f32_16x16x32_bf16 v[68:71], v[116:119], v[148:151], v[68:71]
    ds_read_b64_tr_b16 v[100:101], v12 offset:40960
    v_mfma_f32_16x16x32_bf16 v[68:71], v[112:115], v[132:135], v[68:71]
    ds_read_b64_tr_b16 v[102:103], v12 offset:45056
    v_mfma_f32_16x16x32_bf16 v[72:75], v[112:115], v[136:139], v[72:75]
    ds_read_b128 v[160:163], v17 offset:49152
    v_mfma_f32_16x16x32_bf16 v[72:75], v[116:119], v[152:155], v[72:75]
    ds_read_b128 v[176:179], v17 offset:57344
    v_mfma_f32_16x16x32_bf16 v[76:79], v[116:119], v[156:159], v[76:79]
    ds_read_b128 v[164:167], v17 offset:50176
    v_mfma_f32_16x16x32_bf16 v[76:79], v[112:115], v[140:143], v[76:79]
    ds_read_b128 v[180:183], v17 offset:58368
    v_mfma_f32_16x16x32_bf16 v[92:95], v[120:123], v[140:143], v[92:95]
    ds_read_b128 v[168:171], v17 offset:51200
    v_mfma_f32_16x16x32_bf16 v[92:95], v[124:127], v[156:159], v[92:95]
    ds_read_b128 v[184:187], v17 offset:59392
    v_mfma_f32_16x16x32_bf16 v[88:91], v[124:127], v[152:155], v[88:91]
    ds_read_b128 v[172:175], v17 offset:52224
    v_mfma_f32_16x16x32_bf16 v[88:91], v[120:123], v[136:139], v[88:91]
    ds_read_b128 v[188:191], v17 offset:60416
    v_mfma_f32_16x16x32_bf16 v[84:87], v[120:123], v[132:135], v[84:87]
    v_mfma_f32_16x16x32_bf16 v[84:87], v[124:127], v[148:151], v[84:87]
    v_mfma_f32_16x16x32_bf16 v[80:83], v[124:127], v[144:147], v[80:83]
    v_mfma_f32_16x16x32_bf16 v[80:83], v[120:123], v[128:131], v[80:83]
    s_waitcnt lgkmcnt(0)
    v_mfma_f32_16x16x32_bf16 v[32:35], v[96:99], v[160:163], v[32:35]
    ds_read_b64_tr_b16 v[104:105], v13 offset:32768
    v_mfma_f32_16x16x32_bf16 v[32:35], v[100:103], v[176:179], v[32:35]
    ds_read_b64_tr_b16 v[106:107], v13 offset:36864
    v_mfma_f32_16x16x32_bf16 v[36:39], v[100:103], v[180:183], v[36:39]
    ds_read_b64_tr_b16 v[108:109], v13 offset:40960
    v_mfma_f32_16x16x32_bf16 v[36:39], v[96:99], v[164:167], v[36:39]
    ds_read_b64_tr_b16 v[110:111], v13 offset:45056
    v_mfma_f32_16x16x32_bf16 v[40:43], v[96:99], v[168:171], v[40:43]
    ds_read_b64_tr_b16 v[112:113], v14 offset:32768
    v_mfma_f32_16x16x32_bf16 v[40:43], v[100:103], v[184:187], v[40:43]
    ds_read_b64_tr_b16 v[114:115], v14 offset:36864
    v_mfma_f32_16x16x32_bf16 v[44:47], v[100:103], v[188:191], v[44:47]
    ds_read_b64_tr_b16 v[116:117], v14 offset:40960
    v_mfma_f32_16x16x32_bf16 v[44:47], v[96:99], v[172:175], v[44:47]
    ds_read_b64_tr_b16 v[118:119], v14 offset:45056
    s_waitcnt lgkmcnt(4)
    v_mfma_f32_16x16x32_bf16 v[60:63], v[104:107], v[172:175], v[60:63]
    ds_read_b64_tr_b16 v[120:121], v15 offset:32768
    v_mfma_f32_16x16x32_bf16 v[60:63], v[108:111], v[188:191], v[60:63]
    ds_read_b64_tr_b16 v[122:123], v15 offset:36864
    v_mfma_f32_16x16x32_bf16 v[56:59], v[108:111], v[184:187], v[56:59]
    ds_read_b64_tr_b16 v[124:125], v15 offset:40960
    v_mfma_f32_16x16x32_bf16 v[56:59], v[104:107], v[168:171], v[56:59]
    ds_read_b64_tr_b16 v[126:127], v15 offset:45056
    v_mfma_f32_16x16x32_bf16 v[52:55], v[104:107], v[164:167], v[52:55]
    v_mfma_f32_16x16x32_bf16 v[52:55], v[108:111], v[180:183], v[52:55]
    v_mfma_f32_16x16x32_bf16 v[48:51], v[108:111], v[176:179], v[48:51]
    v_mfma_f32_16x16x32_bf16 v[48:51], v[104:107], v[160:163], v[48:51]
    s_waitcnt lgkmcnt(0)
    s_barrier
    s_cmp_eq_u32 s65, s69
    s_cbranch_scc1 L_c_epi2
    v_mfma_f32_16x16x32_bf16 v[64:67], v[112:115], v[160:163], v[64:67]
    ds_read_b64_tr_b16 v[96:97], v8 offset:0
    v_mfma_f32_16x16x32_bf16 v[64:67], v[116:119], v[176:179], v[64:67]
    ds_read_b64_tr_b16 v[98:99], v8 offset:4096
    v_mfma_f32_16x16x32_bf16 v[68:71], v[116:119], v[180:183], v[68:71]
    ds_read_b64_tr_b16 v[100:101], v8 offset:8192
    v_mfma_f32_16x16x32_bf16 v[68:71], v[112:115], v[164:167], v[68:71]
    ds_read_b64_tr_b16 v[102:103], v8 offset:12288
    v_mfma_f32_16x16x32_bf16 v[72:75], v[112:115], v[168:171], v[72:75]
    ds_read_b128 v[128:131], v16 offset:16384
    v_mfma_f32_16x16x32_bf16 v[72:75], v[116:119], v[184:187], v[72:75]
    ds_read_b128 v[144:147], v16 offset:24576
    v_mfma_f32_16x16x32_bf16 v[76:79], v[116:119], v[188:191], v[76:79]
    ds_read_b128 v[132:135], v16 offset:17408
    v_mfma_f32_16x16x32_bf16 v[76:79], v[112:115], v[172:175], v[76:79]
    ds_read_b128 v[148:151], v16 offset:25600
    v_mfma_f32_16x16x32_bf16 v[92:95], v[120:123], v[172:175], v[92:95]
    ds_read_b128 v[136:139], v16 offset:18432
    v_mfma_f32_16x16x32_bf16 v[92:95], v[124:127], v[188:191], v[92:95]
    ds_read_b128 v[152:155], v16 offset:26624
    v_mfma_f32_16x16x32_bf16 v[88:91], v[124:127], v[184:187], v[88:91]
    ds_read_b128 v[140:143], v16 offset:19456
    v_mfma_f32_16x16x32_bf16 v[88:91], v[120:123], v[168:171], v[88:91]
    ds_read_b128 v[156:159], v16 offset:27648
    v_mfma_f32_16x16x32_bf16 v[84:87], v[120:123], v[164:167], v[84:87]
    v_mfma_f32_16x16x32_bf16 v[84:87], v[124:127], v[180:183], v[84:87]
    v_mfma_f32_16x16x32_bf16 v[80:83], v[124:127], v[176:179], v[80:83]
    v_mfma_f32_16x16x32_bf16 v[80:83], v[120:123], v[160:163], v[80:83]
    s_sub_u32 s65, s65, 1
    s_cmp_lg_u32 s65, 0
    s_cbranch_scc1 L_c_loop
    s_waitcnt lgkmcnt(0)
    s_nop 1
    v_pk_fma_f32 v[96:97], v[32:33], v[32:33], v[22:23]
    v_pk_fma_f32 v[98:99], v[34:35], v[34:35], v[22:23]
    v_pk_fma_f32 v[100:101], v[48:49], v[48:49], v[22:23]
    v_pk_fma_f32 v[102:103], v[50:51], v[50:51], v[22:23]
    v_pk_mul_f32 v[96:97], v[96:97], v[32:33] neg_lo:[1,0] neg_hi:[1,0]
    v_pk_mul_f32 v[98:99], v[98:99], v[34:35] neg_lo:[1,0] neg_hi:[1,0]
    v_pk_mul_f32 v[100:101], v[100:101], v[48:49] neg_lo:[1,0] neg_hi:[1,0]
    v_pk_mul_f32 v[102:103], v[102:103], v[50:51] neg_lo:[1,0] neg_hi:[1,0]
    v_exp_f32 v96, v96
    v_exp_f32 v97, v97
    v_exp_f32 v98, v98
    v_exp_f32 v99, v99
    v_exp_f32 v100, v100
    v_exp_f32 v101, v101
    v_exp_f32 v102, v102
    v_exp_f32 v103, v103
    v_pk_fma_f32 v[96:97], v[96:97], v[24:25], v[24:25]
    v_pk_fma_f32 v[98:99], v[98:99], v[24:25], v[24:25]
    v_pk_fma_f32 v[100:101], v[100:101], v[24:25], v[24:25]
    v_pk_fma_f32 v[102:103], v[102:103], v[24:25], v[24:25]
    v_rcp_f32 v96, v96
    v_rcp_f32 v97, v97
    v_rcp_f32 v98, v98
    v_rcp_f32 v99, v99
    v_rcp_f32 v100, v100
    v_rcp_f32 v101, v101
    v_rcp_f32 v102, v102
    v_rcp_f32 v103, v103
    v_pk_mul_f32 v[96:97], v[96:97], v[32:33]
    v_pk_mul_f32 v[98:99], v[98:99], v[34:35]
    v_pk_mul_f32 v[100:101], v[100:101], v[48:49]
    v_pk_mul_f32 v[102:103], v[102:103], v[50:51]
    v_cvt_pk_bf16_f32 v128, v96, v97
    v_cvt_pk_bf16_f32 v129, v98, v99
    v_cvt_pk_bf16_f32 v130, v100, v101
    v_cvt_pk_bf16_f32 v131, v102, v103
    buffer_store_dwordx4 v[128:131], v4, s[44:47], s48 offen offset:0 sc1
    v_pk_fma_f32 v[112:113], v[36:37], v[36:37], v[22:23]
    v_pk_fma_f32 v[114:115], v[38:39], v[38:39], v[22:23]
    v_pk_fma_f32 v[116:117], v[52:53], v[52:53], v[22:23]
    v_pk_fma_f32 v[118:119], v[54:55], v[54:55], v[22:23]
    v_pk_mul_f32 v[112:113], v[112:113], v[36:37] neg_lo:[1,0] neg_hi:[1,0]
    v_pk_mul_f32 v[114:115], v[114:115], v[38:39] neg_lo:[1,0] neg_hi:[1,0]
    v_pk_mul_f32 v[116:117], v[116:117], v[52:53] neg_lo:[1,0] neg_hi:[1,0]
    v_pk_mul_f32 v[118:119], v[118:119], v[54:55] neg_lo:[1,0] neg_hi:[1,0]
    v_exp_f32 v112, v112
    v_exp_f32 v113, v113
    v_exp_f32 v114, v114
    v_exp_f32 v115, v115
    v_exp_f32 v116, v116
    v_exp_f32 v117, v117
    v_exp_f32 v118, v118
    v_exp_f32 v119, v119
    v_pk_fma_f32 v[112:113], v[112:113], v[24:25], v[24:25]
    v_pk_fma_f32 v[114:115], v[114:115], v[24:25], v[24:25]
    v_pk_fma_f32 v[116:117], v[116:117], v[24:25], v[24:25]
    v_pk_fma_f32 v[118:119], v[118:119], v[24:25], v[24:25]
    v_rcp_f32 v112, v112
    v_rcp_f32 v113, v113
    v_rcp_f32 v114, v114
    v_rcp_f32 v115, v115
    v_rcp_f32 v116, v116
    v_rcp_f32 v117, v117
    v_rcp_f32 v118, v118
    v_rcp_f32 v119, v119
    v_pk_mul_f32 v[112:113], v[112:113], v[36:37]
    v_pk_mul_f32 v[114:115], v[114:115], v[38:39]
    v_pk_mul_f32 v[116:117], v[116:117], v[52:53]
    v_pk_mul_f32 v[118:119], v[118:119], v[54:55]
    v_cvt_pk_bf16_f32 v132, v112, v113
    v_cvt_pk_bf16_f32 v133, v114, v115
    v_cvt_pk_bf16_f32 v134, v116, v117
    v_cvt_pk_bf16_f32 v135, v118, v119
    buffer_store_dwordx4 v[132:135], v4, s[44:47], s48 offen offset:1024 sc1
    v_pk_fma_f32 v[96:97], v[40:41], v[40:41], v[22:23]
    v_pk_fma_f32 v[98:99], v[42:43], v[42:43], v[22:23]
    v_pk_fma_f32 v[100:101], v[56:57], v[56:57], v[22:23]
    v_pk_fma_f32 v[102:103], v[58:59], v[58:59], v[22:23]
    v_pk_mul_f32 v[96:97], v[96:97], v[40:41] neg_lo:[1,0] neg_hi:[1,0]
    v_pk_mul_f32 v[98:99], v[98:99], v[42:43] neg_lo:[1,0] neg_hi:[1,0]
    v_pk_mul_f32 v[100:101], v[100:101], v[56:57] neg_lo:[1,0] neg_hi:[1,0]
    v_pk_mul_f32 v[102:103], v[102:103], v[58:59] neg_lo:[1,0] neg_hi:[1,0]
    v_exp_f32 v96, v96
    v_exp_f32 v97, v97
    v_exp_f32 v98, v98
    v_exp_f32 v99, v99
    v_exp_f32 v100, v100
    v_exp_f32 v101, v101
    v_exp_f32 v102, v102
    v_exp_f32 v103, v103
    v_pk_fma_f32 v[96:97], v[96:97], v[24:25], v[24:25]
    v_pk_fma_f32 v[98:99], v[98:99], v[24:25], v[24:25]
    v_pk_fma_f32 v[100:101], v[100:101], v[24:25], v[24:25]
    v_pk_fma_f32 v[102:103], v[102:103], v[24:25], v[24:25]
    v_rcp_f32 v96, v96
    v_rcp_f32 v97, v97
    v_rcp_f32 v98, v98
    v_rcp_f32 v99, v99
    v_rcp_f32 v100, v100
    v_rcp_f32 v101, v101
    v_rcp_f32 v102, v102
    v_rcp_f32 v103, v103
    v_pk_mul_f32 v[96:97], v[96:97], v[40:41]
    v_pk_mul_f32 v[98:99], v[98:99], v[42:43]
    v_pk_mul_f32 v[100:101], v[100:101], v[56:57]
    v_pk_mul_f32 v[102:103], v[102:103], v[58:59]
    v_cvt_pk_bf16_f32 v136, v96, v97
    v_cvt_pk_bf16_f32 v137, v98, v99
    v_cvt_pk_bf16_f32 v138, v100, v101
    v_cvt_pk_bf16_f32 v139, v102, v103
    buffer_store_dwordx4 v[136:139], v4, s[44:47], s48 offen offset:2048 sc1
    v_pk_fma_f32 v[112:113], v[44:45], v[44:45], v[22:23]
    v_pk_fma_f32 v[114:115], v[46:47], v[46:47], v[22:23]
    v_pk_fma_f32 v[116:117], v[60:61], v[60:61], v[22:23]
    v_pk_fma_f32 v[118:119], v[62:63], v[62:63], v[22:23]
    v_pk_mul_f32 v[112:113], v[112:113], v[44:45] neg_lo:[1,0] neg_hi:[1,0]
    v_pk_mul_f32 v[114:115], v[114:115], v[46:47] neg_lo:[1,0] neg_hi:[1,0]
    v_pk_mul_f32 v[116:117], v[116:117], v[60:61] neg_lo:[1,0] neg_hi:[1,0]
    v_pk_mul_f32 v[118:119], v[118:119], v[62:63] neg_lo:[1,0] neg_hi:[1,0]
    v_exp_f32 v112, v112
    v_exp_f32 v113, v113
    v_exp_f32 v114, v114
    v_exp_f32 v115, v115
    v_exp_f32 v116, v116
    v_exp_f32 v117, v117
    v_exp_f32 v118, v118
    v_exp_f32 v119, v119
    v_pk_fma_f32 v[112:113], v[112:113], v[24:25], v[24:25]
    v_pk_fma_f32 v[114:115], v[114:115], v[24:25], v[24:25]
    v_pk_fma_f32 v[116:117], v[116:117], v[24:25], v[24:25]
    v_pk_fma_f32 v[118:119], v[118:119], v[24:25], v[24:25]
    v_rcp_f32 v112, v112
    v_rcp_f32 v113, v113
    v_rcp_f32 v114, v114
    v_rcp_f32 v115, v115
    v_rcp_f32 v116, v116
    v_rcp_f32 v117, v117
    v_rcp_f32 v118, v118
    v_rcp_f32 v119, v119
    v_pk_mul_f32 v[112:113], v[112:113], v[44:45]
    v_pk_mul_f32 v[114:115], v[114:115], v[46:47]
    v_pk_mul_f32 v[116:117], v[116:117], v[60:61]
    v_pk_mul_f32 v[118:119], v[118:119], v[62:63]
    v_cvt_pk_bf16_f32 v140, v112, v113
    v_cvt_pk_bf16_f32 v141, v114, v115
    v_cvt_pk_bf16_f32 v142, v116, v117
    v_cvt_pk_bf16_f32 v143, v118, v119
    buffer_store_dwordx4 v[140:143], v4, s[44:47], s48 offen offset:3072 sc1
    v_pk_fma_f32 v[96:97], v[64:65], v[64:65], v[22:23]
    v_pk_fma_f32 v[98:99], v[66:67], v[66:67], v[22:23]
    v_pk_fma_f32 v[100:101], v[80:81], v[80:81], v[22:23]
    v_pk_fma_f32 v[102:103], v[82:83], v[82:83], v[22:23]
    v_pk_mul_f32 v[96:97], v[96:97], v[64:65] neg_lo:[1,0] neg_hi:[1,0]
    v_pk_mul_f32 v[98:99], v[98:99], v[66:67] neg_lo:[1,0] neg_hi:[1,0]
    v_pk_mul_f32 v[100:101], v[100:101], v[80:81] neg_lo:[1,0] neg_hi:[1,0]
    v_pk_mul_f32 v[102:103], v[102:103], v[82:83] neg_lo:[1,0] neg_hi:[1,0]
    v_exp_f32 v96, v96
    v_exp_f32 v97, v97
    v_exp_f32 v98, v98
    v_exp_f32 v99, v99
    v_exp_f32 v100, v100
    v_exp_f32 v101, v101
    v_exp_f32 v102, v102
    v_exp_f32 v103, v103
    v_pk_fma_f32 v[96:97], v[96:97], v[24:25], v[24:25]
    v_pk_fma_f32 v[98:99], v[98:99], v[24:25], v[24:25]
    v_pk_fma_f32 v[100:101], v[100:101], v[24:25], v[24:25]
    v_pk_fma_f32 v[102:103], v[102:103], v[24:25], v[24:25]
    v_rcp_f32 v96, v96
    v_rcp_f32 v97, v97
    v_rcp_f32 v98, v98
    v_rcp_f32 v99, v99
    v_rcp_f32 v100, v100
    v_rcp_f32 v101, v101
    v_rcp_f32 v102, v102
    v_rcp_f32 v103, v103
    v_pk_mul_f32 v[96:97], v[96:97], v[64:65]
    v_pk_mul_f32 v[98:99], v[98:99], v[66:67]
    v_pk_mul_f32 v[100:101], v[100:101], v[80:81]
    v_pk_mul_f32 v[102:103], v[102:103], v[82:83]
    v_cvt_pk_bf16_f32 v144, v96, v97
    v_cvt_pk_bf16_f32 v145, v98, v99
    v_cvt_pk_bf16_f32 v146, v100, v101
    v_cvt_pk_bf16_f32 v147, v102, v103
    buffer_store_dwordx4 v[144:147], v4, s[44:47], s49 offen offset:0 sc1
    v_pk_fma_f32 v[112:113], v[68:69], v[68:69], v[22:23]
    v_pk_fma_f32 v[114:115], v[70:71], v[70:71], v[22:23]
    v_pk_fma_f32 v[116:117], v[84:85], v[84:85], v[22:23]
    v_pk_fma_f32 v[118:119], v[86:87], v[86:87], v[22:23]
    v_pk_mul_f32 v[112:113], v[112:113], v[68:69] neg_lo:[1,0] neg_hi:[1,0]
    v_pk_mul_f32 v[114:115], v[114:115], v[70:71] neg_lo:[1,0] neg_hi:[1,0]
    v_pk_mul_f32 v[116:117], v[116:117], v[84:85] neg_lo:[1,0] neg_hi:[1,0]
    v_pk_mul_f32 v[118:119], v[118:119], v[86:87] neg_lo:[1,0] neg_hi:[1,0]
    v_exp_f32 v112, v112
    v_exp_f32 v113, v113
    v_exp_f32 v114, v114
    v_exp_f32 v115, v115
    v_exp_f32 v116, v116
    v_exp_f32 v117, v117
    v_exp_f32 v118, v118
    v_exp_f32 v119, v119
    v_pk_fma_f32 v[112:113], v[112:113], v[24:25], v[24:25]
    v_pk_fma_f32 v[114:115], v[114:115], v[24:25], v[24:25]
    v_pk_fma_f32 v[116:117], v[116:117], v[24:25], v[24:25]
    v_pk_fma_f32 v[118:119], v[118:119], v[24:25], v[24:25]
    v_rcp_f32 v112, v112
    v_rcp_f32 v113, v113
    v_rcp_f32 v114, v114
    v_rcp_f32 v115, v115
    v_rcp_f32 v116, v116
    v_rcp_f32 v117, v117
    v_rcp_f32 v118, v118
    v_rcp_f32 v119, v119
    v_pk_mul_f32 v[112:113], v[112:113], v[68:69]
    v_pk_mul_f32 v[114:115], v[114:115], v[70:71]
    v_pk_mul_f32 v[116:117], v[116:117], v[84:85]
    v_pk_mul_f32 v[118:119], v[118:119], v[86:87]
    v_cvt_pk_bf16_f32 v148, v112, v113
    v_cvt_pk_bf16_f32 v149, v114, v115
    v_cvt_pk_bf16_f32 v150, v116, v117
    v_cvt_pk_bf16_f32 v151, v118, v119
    buffer_store_dwordx4 v[148:151], v4, s[44:47], s49 offen offset:1024 sc1
    v_pk_fma_f32 v[96:97], v[72:73], v[72:73], v[22:23]
    v_pk_fma_f32 v[98:99], v[74:75], v[74:75], v[22:23]
    v_pk_fma_f32 v[100:101], v[88:89], v[88:89], v[22:23]
    v_pk_fma_f32 v[102:103], v[90:91], v[90:91], v[22:23]
    v_pk_mul_f32 v[96:97], v[96:97], v[72:73] neg_lo:[1,0] neg_hi:[1,0]
    v_pk_mul_f32 v[98:99], v[98:99], v[74:75] neg_lo:[1,0] neg_hi:[1,0]
    v_pk_mul_f32 v[100:101], v[100:101], v[88:89] neg_lo:[1,0] neg_hi:[1,0]
    v_pk_mul_f32 v[102:103], v[102:103], v[90:91] neg_lo:[1,0] neg_hi:[1,0]
    v_exp_f32 v96, v96
    v_exp_f32 v97, v97
    v_exp_f32 v98, v98
    v_exp_f32 v99, v99
    v_exp_f32 v100, v100
    v_exp_f32 v101, v101
    v_exp_f32 v102, v102
    v_exp_f32 v103, v103
    v_pk_fma_f32 v[96:97], v[96:97], v[24:25], v[24:25]
    v_pk_fma_f32 v[98:99], v[98:99], v[24:25], v[24:25]
    v_pk_fma_f32 v[100:101], v[100:101], v[24:25], v[24:25]
    v_pk_fma_f32 v[102:103], v[102:103], v[24:25], v[24:25]
    v_rcp_f32 v96, v96
    v_rcp_f32 v97, v97
    v_rcp_f32 v98, v98
    v_rcp_f32 v99, v99
    v_rcp_f32 v100, v100
    v_rcp_f32 v101, v101
    v_rcp_f32 v102, v102
    v_rcp_f32 v103, v103
    v_pk_mul_f32 v[96:97], v[96:97], v[72:73]
    v_pk_mul_f32 v[98:99], v[98:99], v[74:75]
    v_pk_mul_f32 v[100:101], v[100:101], v[88:89]
    v_pk_mul_f32 v[102:103], v[102:103], v[90:91]
    v_cvt_pk_bf16_f32 v152, v96, v97
    v_cvt_pk_bf16_f32 v153, v98, v99
    v_cvt_pk_bf16_f32 v154, v100, v101
    v_cvt_pk_bf16_f32 v155, v102, v103
    buffer_store_dwordx4 v[152:155], v4, s[44:47], s49 offen offset:2048 sc1
    s_waitcnt vmcnt(3)
    s_mov_b64 exec, 1
    buffer_store_dword v21, v20, s[36:39], s52 offen sc1
    s_mov_b64 exec, -1
    v_pk_fma_f32 v[112:113], v[76:77], v[76:77], v[22:23]
    v_pk_fma_f32 v[114:115], v[78:79], v[78:79], v[22:23]
    v_pk_fma_f32 v[116:117], v[92:93], v[92:93], v[22:23]
    v_pk_fma_f32 v[118:119], v[94:95], v[94:95], v[22:23]
    v_pk_mul_f32 v[112:113], v[112:113], v[76:77] neg_lo:[1,0] neg_hi:[1,0]
    v_pk_mul_f32 v[114:115], v[114:115], v[78:79] neg_lo:[1,0] neg_hi:[1,0]
    v_pk_mul_f32 v[116:117], v[116:117], v[92:93] neg_lo:[1,0] neg_hi:[1,0]
    v_pk_mul_f32 v[118:119], v[118:119], v[94:95] neg_lo:[1,0] neg_hi:[1,0]
    v_exp_f32 v112, v112
    v_exp_f32 v113, v113
    v_exp_f32 v114, v114
    v_exp_f32 v115, v115
    v_exp_f32 v116, v116
    v_exp_f32 v117, v117
    v_exp_f32 v118, v118
    v_exp_f32 v119, v119
    v_pk_fma_f32 v[112:113], v[112:113], v[24:25], v[24:25]
    v_pk_fma_f32 v[114:115], v[114:115], v[24:25], v[24:25]
    v_pk_fma_f32 v[116:117], v[116:117], v[24:25], v[24:25]
    v_pk_fma_f32 v[118:119], v[118:119], v[24:25], v[24:25]
    v_rcp_f32 v112, v112
    v_rcp_f32 v113, v113
    v_rcp_f32 v114, v114
    v_rcp_f32 v115, v115
    v_rcp_f32 v116, v116
    v_rcp_f32 v117, v117
    v_rcp_f32 v118, v118
    v_rcp_f32 v119, v119
    v_pk_mul_f32 v[112:113], v[112:113], v[76:77]
    v_pk_mul_f32 v[114:115], v[114:115], v[78:79]
    v_pk_mul_f32 v[116:117], v[116:117], v[92:93]
    v_pk_mul_f32 v[118:119], v[118:119], v[94:95]
    v_cvt_pk_bf16_f32 v156, v112, v113
    v_cvt_pk_bf16_f32 v157, v114, v115
    v_cvt_pk_bf16_f32 v158, v116, v117
    v_cvt_pk_bf16_f32 v159, v118, v119
    buffer_store_dwordx4 v[156:159], v4, s[44:47], s49 offen offset:3072 sc1
    s_waitcnt vmcnt(0)
    s_mov_b64 exec, 1
    buffer_store_dword v21, v20, s[36:39], s53 offen sc1
    s_mov_b64 exec, -1
    s_barrier
L_c_g2:
    s_waitcnt vmcnt(0)
    s_barrier
L_c_g2p:
    v_lshrrev_b32 v3, 4, v2
    v_and_b32 v4, 15, v2
    v_lshrrev_b32 v6, 2, v4
    v_lshl_add_u32 v7, v3, 2, v6
    v_and_b32 v18, 7, v7
    v_lshlrev_b32 v7, 8, v7
    v_and_b32 v19, 3, v4
    v_lshl_add_u32 v7, v19, 3, v7
    s_lshl_b32 s50, s63, 2
    s_lshl_b32 s51, s27, 1
    s_xor_b32 s50, s50, s51
    s_xor_b32 s50, s50, 2
    s_xor_b32 s51, s50, 0
    v_xor_b32 v19, s51, v18
    v_lshl_add_u32 v8, v19, 5, v7
    v_add_u32 v12, 0x10000, v8
    s_xor_b32 s51, s50, 1
    v_xor_b32 v19, s51, v18
    v_lshl_add_u32 v9, v19, 5, v7
    v_add_u32 v13, 0x10000, v9
    s_xor_b32 s51, s50, 2
    v_xor_b32 v19, s51, v18
    v_lshl_add_u32 v10, v19, 5, v7
    v_add_u32 v14, 0x10000, v10
    s_xor_b32 s51, s50, 3
    v_xor_b32 v19, s51, v18
    v_lshl_add_u32 v11, v19, 5, v7
    v_add_u32 v15, 0x10000, v11
    s_lshl_b32 s50, s62, 12
    v_lshl_add_u32 v16, v2, 4, s50
    v_add_u32 v17, 0x10000, v16
    v_mov_b32 v32, 0
    v_mov_b32 v36, v32
    v_mov_b32 v40, v32
    v_mov_b32 v44, v32
    v_mov_b32 v33, 0
    v_mov_b32 v37, v33
    v_mov_b32 v41, v33
    v_mov_b32 v45, v33
    v_mov_b32 v34, 0
    v_mov_b32 v38, v34
    v_mov_b32 v42, v34
    v_mov_b32 v46, v34
    v_mov_b32 v35, 0
    v_mov_b32 v39, v35
    v_mov_b32 v43, v35
    v_mov_b32 v47, v35
    v_mov_b32 v48, 0
    v_mov_b32 v52, v48
    v_mov_b32 v56, v48
    v_mov_b32 v60, v48
    v_mov_b32 v49, 0
    v_mov_b32 v53, v49
    v_mov_b32 v57, v49
    v_mov_b32 v61, v49
    v_mov_b32 v50, 0
    v_mov_b32 v54, v50
    v_mov_b32 v58, v50
    v_mov_b32 v62, v50
    v_mov_b32 v51, 0
    v_mov_b32 v55, v51
    v_mov_b32 v59, v51
    v_mov_b32 v63, v51
    v_lshlrev_b32 v64, 16, v192
    v_mov_b32 v68, v64
    v_mov_b32 v72, v64
    v_mov_b32 v76, v64
    v_and_b32 v65, 0xffff0000, v192
    v_mov_b32 v69, v65
    v_mov_b32 v73, v65
    v_mov_b32 v77, v65
    v_lshlrev_b32 v66, 16, v193
    v_mov_b32 v70, v66
    v_mov_b32 v74, v66
    v_mov_b32 v78, v66
    v_and_b32 v67, 0xffff0000, v193
    v_mov_b32 v71, v67
    v_mov_b32 v75, v67
    v_mov_b32 v79, v67
    v_lshlrev_b32 v80, 16, v194
    v_mov_b32 v84, v80
    v_mov_b32 v88, v80
    v_mov_b32 v92, v80
    v_and_b32 v81, 0xffff0000, v194
    v_mov_b32 v85, v81
    v_mov_b32 v89, v81
    v_mov_b32 v93, v81
    v_lshlrev_b32 v82, 16, v195
    v_mov_b32 v86, v82
    v_mov_b32 v90, v82
    v_mov_b32 v94, v82
    v_and_b32 v83, 0xffff0000, v195
    v_mov_b32 v87, v83
    v_mov_b32 v91, v83
    v_mov_b32 v95, v83
    s_mov_b32 s44, s14
    s_mov_b32 s45, s15
    s_mov_b32 s46, 4194304
    s_mov_b32 s47, 0x20000
    v_lshlrev_b32 v3, 13, v3
    v_lshl_add_u32 v20, v4, 3, v3
    v_add_u32 v21, 4096, v20
    s_lshl_b32 s56, s25, 7
    s_lshl_b32 s57, s63, 6
    s_add_u32 s56, s56, s57
    s_lshl_b32 s57, s27, 5
    s_add_u32 s56, s56, s57
    s_lshl_b32 s56, s56, 11
    s_lshl_b32 s57, s26, 8
    s_add_u32 s56, s56, s57
    s_lshl_b32 s57, s62, 7
    s_add_u32 s56, s56, s57
    s_xor_b32 s52, s56, 0x10000
    s_add_u32 s53, s52, 32768
    s_add_u32 s57, s56, 32768
    v_mov_b32 v22, 0
    v_mov_b32 v23, s20
    s_mov_b32 s68, 2
    s_mov_b32 s65, 7
    s_mov_b32 s69, 1
    s_branch L_c_main
L_c_epi2:
    s_waitcnt vmcnt(0)
    v_readfirstlane_b32 s61, v30
    s_cmp_eq_u32 s61, s64
    s_cbranch_scc0 L_c_far
    v_mfma_f32_16x16x32_bf16 v[64:67], v[112:115], v[160:163], v[64:67]
    v_cvt_pk_bf16_f32 v128, v32, v36
    v_cvt_pk_bf16_f32 v129, v40, v44
    v_mfma_f32_16x16x32_bf16 v[64:67], v[116:119], v[176:179], v[64:67]
    buffer_store_dwordx2 v[128:129], v20, s[44:47], s52 offen offset:0
    v_mfma_f32_16x16x32_bf16 v[68:71], v[116:119], v[180:183], v[68:71]
    v_cvt_pk_bf16_f32 v130, v33, v37
    v_cvt_pk_bf16_f32 v131, v41, v45
    v_mfma_f32_16x16x32_bf16 v[68:71], v[112:115], v[164:167], v[68:71]
    buffer_store_dwordx2 v[130:131], v20, s[44:47], s52 offen offset:2048
    v_mfma_f32_16x16x32_bf16 v[72:75], v[112:115], v[168:171], v[72:75]
    v_cvt_pk_bf16_f32 v132, v34, v38
    v_cvt_pk_bf16_f32 v133, v42, v46
    v_mfma_f32_16x16x32_bf16 v[72:75], v[116:119], v[184:187], v[72:75]
    buffer_store_dwordx2 v[132:133], v21, s[44:47], s52 offen offset:0
    v_mfma_f32_16x16x32_bf16 v[76:79], v[116:119], v[188:191], v[76:79]
    v_cvt_pk_bf16_f32 v134, v35, v39
    v_cvt_pk_bf16_f32 v135, v43, v47
    v_mfma_f32_16x16x32_bf16 v[76:79], v[112:115], v[172:175], v[76:79]
    buffer_store_dwordx2 v[134:135], v21, s[44:47], s52 offen offset:2048
    v_mfma_f32_16x16x32_bf16 v[92:95], v[120:123], v[172:175], v[92:95]
    v_cvt_pk_bf16_f32 v136, v48, v52
    v_cvt_pk_bf16_f32 v137, v56, v60
    v_mfma_f32_16x16x32_bf16 v[92:95], v[124:127], v[188:191], v[92:95]
    buffer_store_dwordx2 v[136:137], v20, s[44:47], s53 offen offset:0
    v_mfma_f32_16x16x32_bf16 v[88:91], v[124:127], v[184:187], v[88:91]
    v_cvt_pk_bf16_f32 v138, v49, v53
    v_cvt_pk_bf16_f32 v139, v57, v61
    v_mfma_f32_16x16x32_bf16 v[88:91], v[120:123], v[168:171], v[88:91]
    buffer_store_dwordx2 v[138:139], v20, s[44:47], s53 offen offset:2048
    v_mfma_f32_16x16x32_bf16 v[84:87], v[120:123], v[164:167], v[84:87]
    v_cvt_pk_bf16_f32 v140, v50, v54
    v_cvt_pk_bf16_f32 v141, v58, v62
    v_mfma_f32_16x16x32_bf16 v[84:87], v[124:127], v[180:183], v[84:87]
    buffer_store_dwordx2 v[140:141], v21, s[44:47], s53 offen offset:0
    v_mfma_f32_16x16x32_bf16 v[80:83], v[124:127], v[176:179], v[80:83]
    v_cvt_pk_bf16_f32 v142, v51, v55
    v_cvt_pk_bf16_f32 v143, v59, v63
    v_mfma_f32_16x16x32_bf16 v[80:83], v[120:123], v[160:163], v[80:83]
    buffer_store_dwordx2 v[142:143], v21, s[44:47], s53 offen offset:2048
    s_waitcnt vmcnt(0)
    s_mov_b64 exec, 1
    buffer_store_dword v23, v22, s[36:39], s54 offen
    s_branch L_c_sent
L_c_far:
    v_mfma_f32_16x16x32_bf16 v[64:67], v[112:115], v[160:163], v[64:67]
    v_cvt_pk_bf16_f32 v128, v32, v36
    v_cvt_pk_bf16_f32 v129, v40, v44
    v_mfma_f32_16x16x32_bf16 v[64:67], v[116:119], v[176:179], v[64:67]
    buffer_store_dwordx2 v[128:129], v20, s[44:47], s52 offen offset:0 sc1
    v_mfma_f32_16x16x32_bf16 v[68:71], v[116:119], v[180:183], v[68:71]
    v_cvt_pk_bf16_f32 v130, v33, v37
    v_cvt_pk_bf16_f32 v131, v41, v45
    v_mfma_f32_16x16x32_bf16 v[68:71], v[112:115], v[164:167], v[68:71]
    buffer_store_dwordx2 v[130:131], v20, s[44:47], s52 offen offset:2048 sc1
    v_mfma_f32_16x16x32_bf16 v[72:75], v[112:115], v[168:171], v[72:75]
    v_cvt_pk_bf16_f32 v132, v34, v38
    v_cvt_pk_bf16_f32 v133, v42, v46
    v_mfma_f32_16x16x32_bf16 v[72:75], v[116:119], v[184:187], v[72:75]
    buffer_store_dwordx2 v[132:133], v21, s[44:47], s52 offen offset:0 sc1
    v_mfma_f32_16x16x32_bf16 v[76:79], v[116:119], v[188:191], v[76:79]
    v_cvt_pk_bf16_f32 v134, v35, v39
    v_cvt_pk_bf16_f32 v135, v43, v47
    v_mfma_f32_16x16x32_bf16 v[76:79], v[112:115], v[172:175], v[76:79]
    buffer_store_dwordx2 v[134:135], v21, s[44:47], s52 offen offset:2048 sc1
    v_mfma_f32_16x16x32_bf16 v[92:95], v[120:123], v[172:175], v[92:95]
    v_cvt_pk_bf16_f32 v136, v48, v52
    v_cvt_pk_bf16_f32 v137, v56, v60
    v_mfma_f32_16x16x32_bf16 v[92:95], v[124:127], v[188:191], v[92:95]
    buffer_store_dwordx2 v[136:137], v20, s[44:47], s53 offen offset:0 sc1
    v_mfma_f32_16x16x32_bf16 v[88:91], v[124:127], v[184:187], v[88:91]
    v_cvt_pk_bf16_f32 v138, v49, v53
    v_cvt_pk_bf16_f32 v139, v57, v61
    v_mfma_f32_16x16x32_bf16 v[88:91], v[120:123], v[168:171], v[88:91]
    buffer_store_dwordx2 v[138:139], v20, s[44:47], s53 offen offset:2048 sc1
    v_mfma_f32_16x16x32_bf16 v[84:87], v[120:123], v[164:167], v[84:87]
    v_cvt_pk_bf16_f32 v140, v50, v54
    v_cvt_pk_bf16_f32 v141, v58, v62
    v_mfma_f32_16x16x32_bf16 v[84:87], v[124:127], v[180:183], v[84:87]
    buffer_store_dwordx2 v[140:141], v21, s[44:47], s53 offen offset:0 sc1
    v_mfma_f32_16x16x32_bf16 v[80:83], v[124:127], v[176:179], v[80:83]
    v_cvt_pk_bf16_f32 v142, v51, v55
    v_cvt_pk_bf16_f32 v143, v59, v63
    v_mfma_f32_16x16x32_bf16 v[80:83], v[120:123], v[160:163], v[80:83]
    buffer_store_dwordx2 v[142:143], v21, s[44:47], s53 offen offset:2048 sc1
    s_waitcnt vmcnt(0)
    s_mov_b64 exec, 1
    buffer_store_dword v23, v22, s[36:39], s54 offen sc1
L_c_sent:
    s_mov_b32 s59, 0x80000
    s_mov_b64 exec, 1
L_c_p3:
    buffer_load_dword v18, v22, s[36:39], s55 offen sc1
    s_sub_u32 s59, s59, 1
    s_cbranch_scc1 L_c_p3_x
    s_waitcnt vmcnt(0)
L_c_p3_c:
    v_cmp_ne_u32 vcc, s20, v18
    s_cmp_lg_u64 vcc, 0
    s_cbranch_scc1 L_c_p3
L_c_p3_x:
    s_mov_b64 exec, -1
    buffer_load_dwordx2 v[96:97], v20, s[44:47], s56 offen offset:0 sc1
    buffer_load_dwordx2 v[98:99], v20, s[44:47], s56 offen offset:2048 sc1
    buffer_load_dwordx2 v[100:101], v21, s[44:47], s56 offen offset:0 sc1
    buffer_load_dwordx2 v[102:103], v21, s[44:47], s56 offen offset:2048 sc1
    buffer_load_dwordx2 v[104:105], v20, s[44:47], s57 offen offset:0 sc1
    buffer_load_dwordx2 v[106:107], v20, s[44:47], s57 offen offset:2048 sc1
    buffer_load_dwordx2 v[108:109], v21, s[44:47], s57 offen offset:0 sc1
    buffer_load_dwordx2 v[110:111], v21, s[44:47], s57 offen offset:2048 sc1
    s_waitcnt vmcnt(7)
    v_lshlrev_b32 v112, 16, v96
    v_and_b32 v113, 0xffff0000, v96
    v_lshlrev_b32 v114, 16, v97
    v_and_b32 v115, 0xffff0000, v97
    v_add_f32 v64, v64, v112
    v_add_f32 v68, v68, v113
    v_add_f32 v72, v72, v114
    v_add_f32 v76, v76, v115
    v_cvt_pk_bf16_f32 v96, v64, v68
    v_cvt_pk_bf16_f32 v97, v72, v76
    buffer_store_dwordx2 v[96:97], v20, s[44:47], s56 offen offset:0
    s_waitcnt vmcnt(7)
    v_lshlrev_b32 v116, 16, v98
    v_and_b32 v117, 0xffff0000, v98
    v_lshlrev_b32 v118, 16, v99
    v_and_b32 v119, 0xffff0000, v99
    v_add_f32 v65, v65, v116
    v_add_f32 v69, v69, v117
    v_add_f32 v73, v73, v118
    v_add_f32 v77, v77, v119
    v_cvt_pk_bf16_f32 v98, v65, v69
    v_cvt_pk_bf16_f32 v99, v73, v77
    buffer_store_dwordx2 v[98:99], v20, s[44:47], s56 offen offset:2048
    s_waitcnt vmcnt(7)
    v_lshlrev_b32 v112, 16, v100
    v_and_b32 v113, 0xffff0000, v100
    v_lshlrev_b32 v114, 16, v101
    v_and_b32 v115, 0xffff0000, v101
    v_add_f32 v66, v66, v112
    v_add_f32 v70, v70, v113
    v_add_f32 v74, v74, v114
    v_add_f32 v78, v78, v115
    v_cvt_pk_bf16_f32 v100, v66, v70
    v_cvt_pk_bf16_f32 v101, v74, v78
    buffer_store_dwordx2 v[100:101], v21, s[44:47], s56 offen offset:0
    s_waitcnt vmcnt(7)
    v_lshlrev_b32 v116, 16, v102
    v_and_b32 v117, 0xffff0000, v102
    v_lshlrev_b32 v118, 16, v103
    v_and_b32 v119, 0xffff0000, v103
    v_add_f32 v67, v67, v116
    v_add_f32 v71, v71, v117
    v_add_f32 v75, v75, v118
    v_add_f32 v79, v79, v119
    v_cvt_pk_bf16_f32 v102, v67, v71
    v_cvt_pk_bf16_f32 v103, v75, v79
    buffer_store_dwordx2 v[102:103], v21, s[44:47], s56 offen offset:2048
    s_waitcnt vmcnt(7)
    v_lshlrev_b32 v112, 16, v104
    v_and_b32 v113, 0xffff0000, v104
    v_lshlrev_b32 v114, 16, v105
    v_and_b32 v115, 0xffff0000, v105
    v_add_f32 v80, v80, v112
    v_add_f32 v84, v84, v113
    v_add_f32 v88, v88, v114
    v_add_f32 v92, v92, v115
    v_cvt_pk_bf16_f32 v104, v80, v84
    v_cvt_pk_bf16_f32 v105, v88, v92
    buffer_store_dwordx2 v[104:105], v20, s[44:47], s57 offen offset:0
    s_waitcnt vmcnt(7)
    v_lshlrev_b32 v116, 16, v106
    v_and_b32 v117, 0xffff0000, v106
    v_lshlrev_b32 v118, 16, v107
    v_and_b32 v119, 0xffff0000, v107
    v_add_f32 v81, v81, v116
    v_add_f32 v85, v85, v117
    v_add_f32 v89, v89, v118
    v_add_f32 v93, v93, v119
    v_cvt_pk_bf16_f32 v106, v81, v85
    v_cvt_pk_bf16_f32 v107, v89, v93
    buffer_store_dwordx2 v[106:107], v20, s[44:47], s57 offen offset:2048
    s_waitcnt vmcnt(7)
    v_lshlrev_b32 v112, 16, v108
    v_and_b32 v113, 0xffff0000, v108
    v_lshlrev_b32 v114, 16, v109
    v_and_b32 v115, 0xffff0000, v109
    v_add_f32 v82, v82, v112
    v_add_f32 v86, v86, v113
    v_add_f32 v90, v90, v114
    v_add_f32 v94, v94, v115
    v_cvt_pk_bf16_f32 v108, v82, v86
    v_cvt_pk_bf16_f32 v109, v90, v94
    buffer_store_dwordx2 v[108:109], v21, s[44:47], s57 offen offset:0
    s_waitcnt vmcnt(7)
    v_lshlrev_b32 v116, 16, v110
    v_and_b32 v117, 0xffff0000, v110
    v_lshlrev_b32 v118, 16, v111
    v_and_b32 v119, 0xffff0000, v111
    v_add_f32 v83, v83, v116
    v_add_f32 v87, v87, v117
    v_add_f32 v91, v91, v118
    v_add_f32 v95, v95, v119
    v_cvt_pk_bf16_f32 v110, v83, v87
    v_cvt_pk_bf16_f32 v111, v91, v95
    buffer_store_dwordx2 v[110:111], v21, s[44:47], s57 offen offset:2048
    s_endpgm
L_loader:
    s_sub_u32 s62, s3, 4
    s_lshl_b32 s52, s62, 12
    v_and_b32 v2, 63, v0
    s_cmp_ge_u32 s2, 16
    s_cbranch_scc1 L_l_ncw
    s_cmp_ge_u32 s62, 2
    s_cbranch_scc1 L_l_ncw
    s_getpc_b64 s[58:59]
L_l_pc:
    s_sub_u32 s58, s58, L_l_pc-standalone__mixer_token_mlp__prompt_kernel
    s_subb_u32 s59, s59, 0
    s_lshl_b32 s60, s62, 13
    v_lshl_add_u32 v21, v2, 7, s60
    v_min_u32 v21, L_end-standalone__mixer_token_mlp__prompt_kernel, v21
    global_load_dword v31, v21, s[58:59]
L_l_ncw:
    v_lshrrev_b32 v3, 4, v2
    v_and_b32 v4, 15, v2
    v_lshrrev_b32 v5, 1, v4
    v_and_b32 v4, 1, v4
    v_lshlrev_b32 v4, 4, v4
    s_lshr_b32 s48, s2, 2
    s_and_b32 s49, s2, 3
    s_lshl_b32 s50, s48, 5
    s_lshl_b32 s51, s49, 2
    s_add_u32 s50, s50, s51
    s_lshl_b32 s50, s50, 11
    s_lshr_b32 s48, s62, 1
    s_lshl_b32 s48, s48, 15
    s_and_b32 s49, s62, 1
    s_lshl_b32 s49, s49, 12
    s_add_u32 s50, s50, s48
    s_add_u32 s50, s50, s49
    v_lshlrev_b32 v1, 4, v2
    s_waitcnt lgkmcnt(0)
    s_mov_b32 s40, s4
    s_mov_b32 s41, s5
    s_mov_b32 s42, 4194304
    s_mov_b32 s43, 0x20000
    v_add_u32 v76, s52, v1
    s_cmp_ge_u32 s2, 64
    s_cbranch_scc1 L_l_xlate
    buffer_load_dwordx4 v[32:35], v1, s[40:43], s50 offen offset:0
    buffer_load_dwordx4 v[36:39], v1, s[40:43], s50 offen offset:1024
    buffer_load_dwordx4 v[40:43], v1, s[40:43], s50 offen offset:2048
    buffer_load_dwordx4 v[44:47], v1, s[40:43], s50 offen offset:3072
L_l_xlate:
    s_add_u32 s36, s18, 20971520
    s_addc_u32 s37, s19, 0
    s_mov_b32 s38, 655360
    s_mov_b32 s39, 0x20000
    s_load_dword s20, s[36:37], 0
    s_and_b32 s21, s2, 7
    s_lshr_b32 s22, s2, 3
    s_mul_i32 s66, s22, 37
    s_lshr_b32 s66, s66, 8
    s_mul_i32 s67, s66, 7
    s_sub_u32 s69, s22, s67
    s_and_b32 s67, s21, 3
    s_mul_i32 s23, s67, 7
    s_add_u32 s23, s23, s69
    s_and_b32 s26, s21, 4
    s_add_u32 s24, s26, s66
    s_and_b32 s27, s22, 1
    s_lshl_b32 s25, s67, 2
    s_bfe_u32 s66, s22, 0x20001
    s_add_u32 s25, s25, s66
    s_lshr_b32 s66, s22, 3
    s_add_u32 s26, s26, s66
    v_mul_u32_u24 v13, 3641, v2
    v_lshrrev_b32 v13, 16, v13
    v_mul_u32_u24 v14, 18, v13
    v_sub_u32 v14, v2, v14
    s_and_b32 s48, s21, 3
    s_lshr_b32 s49, s21, 2
    s_mul_i32 s58, s48, 14
    s_add_u32 s59, s48, 1
    s_and_b32 s59, s59, 3
    s_lshl_b32 s59, s59, 1
    v_cmp_gt_u32 vcc, 14, v14
    v_add_u32 v16, s58, v14
    v_subrev_u32 v17, 14, v14
    v_lshrrev_b32 v18, 1, v17
    v_lshlrev_b32 v18, 3, v18
    v_and_b32 v17, 1, v17
    v_add3_u32 v17, v17, v18, s59
    v_subrev_u32 v18, 14, v17
    v_min_u32 v17, v17, v18
    v_cmp_gt_u32 s[60:61], 14, v17
    v_add_u32 v17, s58, v17
    v_cndmask_b32 v16, v17, v16, vcc
    s_or_b64 s[60:61], s[60:61], vcc
    s_xor_b32 s58, s49, 1
    v_mov_b32 v17, s58
    v_mov_b32 v18, s49
    v_cndmask_b32 v17, v17, v18, vcc
    v_lshl_add_u32 v17, v13, 1, v17
    v_cmp_gt_u32 vcc, 3, v13
    s_and_b64 vcc, vcc, s[60:61]
    v_mul_u32_u24 v17, 7168, v17
    v_lshl_add_u32 v25, v16, 7, v17
    v_mov_b32 v17, 2147483647
    v_cndmask_b32 v25, v17, v25, vcc
    s_sub_u32 s48, s22, 0
    s_and_b32 s48, s48, 31
    s_mul_i32 s48, s48, 2
    s_add_u32 s48, s48, s62
    s_mul_i32 s55, s48, 43008
    s_mov_b32 s32, s6
    s_mov_b32 s33, s7
    s_mov_b32 s34, 14680064
    s_mov_b32 s35, 0x20000
    s_cmp_ge_u32 s62, 2
    s_cselect_b32 s55, 0x7ff00000, s55
    s_cmp_lt_u32 s2, 64
    s_cbranch_scc1 L_l_xdone
    buffer_load_dwordx4 v[32:35], v1, s[40:43], s50 offen offset:0
    buffer_load_dwordx4 v[36:39], v1, s[40:43], s50 offen offset:1024
    buffer_load_dwordx4 v[40:43], v1, s[40:43], s50 offen offset:2048
    buffer_load_dwordx4 v[44:47], v1, s[40:43], s50 offen offset:3072
L_l_xdone:
    s_and_b32 s56, s24, 6
    s_and_b32 s59, s21, 1
    s_add_u32 s56, s56, s59
    s_lshl_b32 s56, s56, 12
    s_add_u32 s56, s56, 65536
    v_lshrrev_b32 v13, 1, v2
    v_lshlrev_b32 v13, 7, v13
    v_and_b32 v14, 1, v2
    v_lshl_add_u32 v13, v14, 4, v13
    s_lshl_b32 s48, s2, 7
    s_add_u32 s48, s48, 65536
    s_lshl_b32 s49, s2, 8
    s_add_u32 s49, s49, 130944
    s_lshl_b32 s58, s2, 10
    s_add_u32 s58, s58, 392832
    v_lshl_add_u32 v21, v2, 7, s58
    v_lshl_add_u32 v22, v2, 7, s49
    v_cmp_gt_u32 vcc, 3, v2
    v_mov_b32 v23, s48
    s_nop 0
    v_cndmask_b32 v21, v21, v22, vcc
    v_cmp_eq_u32 vcc, 0, v2
    s_nop 1
    v_cndmask_b32 v21, v21, v23, vcc
    s_cmp_eq_u32 s3, 7
    s_cselect_b32 s48, 0, 0x7ff00000
    s_mov_b64 exec, 0x7ff
    buffer_load_dword v31, v21, s[36:39], s48 offen sc1
    s_mov_b64 exec, -1
    s_waitcnt vmcnt(3)
    buffer_load_dword v31, v25, s[32:35], s55 offen
    s_waitcnt vmcnt(4)
    ds_write_b128 v76, v[32:35] offset:16384
    ds_write_b128 v76, v[36:39] offset:17408
    v_readfirstlane_b32 s58, v32
    s_nop 0
    s_lshl_b32 s58, s58, 16
    v_mov_b32 v72, s58
    v_mov_b32 v73, s58
    v_lshlrev_b32 v48, 16, v32
    v_and_b32 v49, 0xffff0000, v32
    v_lshlrev_b32 v50, 16, v33
    v_and_b32 v51, 0xffff0000, v33
    v_lshlrev_b32 v52, 16, v34
    v_and_b32 v53, 0xffff0000, v34
    v_lshlrev_b32 v54, 16, v35
    v_and_b32 v55, 0xffff0000, v35
    v_lshlrev_b32 v56, 16, v36
    v_and_b32 v57, 0xffff0000, v36
    v_lshlrev_b32 v58, 16, v37
    v_and_b32 v59, 0xffff0000, v37
    v_lshlrev_b32 v60, 16, v38
    v_and_b32 v61, 0xffff0000, v38
    v_lshlrev_b32 v62, 16, v39
    v_and_b32 v63, 0xffff0000, v39
    v_pk_add_f32 v[48:49], v[48:49], v[72:73] neg_lo:[0,1] neg_hi:[0,1]
    v_pk_add_f32 v[50:51], v[50:51], v[72:73] neg_lo:[0,1] neg_hi:[0,1]
    v_pk_add_f32 v[52:53], v[52:53], v[72:73] neg_lo:[0,1] neg_hi:[0,1]
    v_pk_add_f32 v[54:55], v[54:55], v[72:73] neg_lo:[0,1] neg_hi:[0,1]
    v_pk_add_f32 v[56:57], v[56:57], v[72:73] neg_lo:[0,1] neg_hi:[0,1]
    v_pk_add_f32 v[58:59], v[58:59], v[72:73] neg_lo:[0,1] neg_hi:[0,1]
    v_pk_add_f32 v[60:61], v[60:61], v[72:73] neg_lo:[0,1] neg_hi:[0,1]
    v_pk_add_f32 v[62:63], v[62:63], v[72:73] neg_lo:[0,1] neg_hi:[0,1]
    v_pk_add_f32 v[64:65], v[48:49], v[50:51]
    v_pk_mul_f32 v[66:67], v[48:49], v[48:49]
    v_pk_fma_f32 v[66:67], v[50:51], v[50:51], v[66:67]
    v_pk_add_f32 v[64:65], v[64:65], v[52:53]
    v_pk_fma_f32 v[66:67], v[52:53], v[52:53], v[66:67]
    v_pk_add_f32 v[64:65], v[64:65], v[54:55]
    v_pk_fma_f32 v[66:67], v[54:55], v[54:55], v[66:67]
    v_pk_add_f32 v[64:65], v[64:65], v[56:57]
    v_pk_fma_f32 v[66:67], v[56:57], v[56:57], v[66:67]
    v_pk_add_f32 v[64:65], v[64:65], v[58:59]
    v_pk_fma_f32 v[66:67], v[58:59], v[58:59], v[66:67]
    v_pk_add_f32 v[64:65], v[64:65], v[60:61]
    v_pk_fma_f32 v[66:67], v[60:61], v[60:61], v[66:67]
    v_pk_add_f32 v[64:65], v[64:65], v[62:63]
    v_pk_fma_f32 v[66:67], v[62:63], v[62:63], v[66:67]
    v_add_f32 v64, v64, v65
    v_add_f32 v66, v66, v67
    s_waitcnt vmcnt(2)
    ds_write_b128 v76, v[40:43] offset:18432
    ds_write_b128 v76, v[44:47] offset:19456
    v_readfirstlane_b32 s59, v40
    s_nop 0
    s_lshl_b32 s59, s59, 16
    v_mov_b32 v74, s59
    v_mov_b32 v75, s59
    v_lshlrev_b32 v48, 16, v40
    v_and_b32 v49, 0xffff0000, v40
    v_lshlrev_b32 v50, 16, v41
    v_and_b32 v51, 0xffff0000, v41
    v_lshlrev_b32 v52, 16, v42
    v_and_b32 v53, 0xffff0000, v42
    v_lshlrev_b32 v54, 16, v43
    v_and_b32 v55, 0xffff0000, v43
    v_lshlrev_b32 v56, 16, v44
    v_and_b32 v57, 0xffff0000, v44
    v_lshlrev_b32 v58, 16, v45
    v_and_b32 v59, 0xffff0000, v45
    v_lshlrev_b32 v60, 16, v46
    v_and_b32 v61, 0xffff0000, v46
    v_lshlrev_b32 v62, 16, v47
    v_and_b32 v63, 0xffff0000, v47
    v_pk_add_f32 v[48:49], v[48:49], v[74:75] neg_lo:[0,1] neg_hi:[0,1]
    v_pk_add_f32 v[50:51], v[50:51], v[74:75] neg_lo:[0,1] neg_hi:[0,1]
    v_pk_add_f32 v[52:53], v[52:53], v[74:75] neg_lo:[0,1] neg_hi:[0,1]
    v_pk_add_f32 v[54:55], v[54:55], v[74:75] neg_lo:[0,1] neg_hi:[0,1]
    v_pk_add_f32 v[56:57], v[56:57], v[74:75] neg_lo:[0,1] neg_hi:[0,1]
    v_pk_add_f32 v[58:59], v[58:59], v[74:75] neg_lo:[0,1] neg_hi:[0,1]
    v_pk_add_f32 v[60:61], v[60:61], v[74:75] neg_lo:[0,1] neg_hi:[0,1]
    v_pk_add_f32 v[62:63], v[62:63], v[74:75] neg_lo:[0,1] neg_hi:[0,1]
    v_pk_add_f32 v[68:69], v[48:49], v[50:51]
    v_pk_mul_f32 v[70:71], v[48:49], v[48:49]
    v_pk_fma_f32 v[70:71], v[50:51], v[50:51], v[70:71]
    v_pk_add_f32 v[68:69], v[68:69], v[52:53]
    v_pk_fma_f32 v[70:71], v[52:53], v[52:53], v[70:71]
    v_pk_add_f32 v[68:69], v[68:69], v[54:55]
    v_pk_fma_f32 v[70:71], v[54:55], v[54:55], v[70:71]
    v_pk_add_f32 v[68:69], v[68:69], v[56:57]
    v_pk_fma_f32 v[70:71], v[56:57], v[56:57], v[70:71]
    v_pk_add_f32 v[68:69], v[68:69], v[58:59]
    v_pk_fma_f32 v[70:71], v[58:59], v[58:59], v[70:71]
    v_pk_add_f32 v[68:69], v[68:69], v[60:61]
    v_pk_fma_f32 v[70:71], v[60:61], v[60:61], v[70:71]
    v_pk_add_f32 v[68:69], v[68:69], v[62:63]
    v_pk_fma_f32 v[70:71], v[62:63], v[62:63], v[70:71]
    v_add_f32 v68, v68, v69
    v_add_f32 v70, v70, v71
    v_cmp_gt_u32 vcc, 32, v2
    s_nop 0
    v_permlane32_swap_b32 v64, v68
    v_permlane32_swap_b32 v66, v70
    v_cndmask_b32 v72, v74, v72, vcc
    v_add_f32 v64, v64, v68
    v_add_f32 v66, v66, v70
    v_mov_b32 v65, v64
    v_mov_b32 v67, v66
    s_nop 1
    v_permlane16_swap_b32 v64, v65
    v_permlane16_swap_b32 v66, v67
    v_add_f32 v64, v64, v65
    v_add_f32 v66, v66, v67
    s_nop 0
    v_add_f32_dpp v64, v64, v64 row_ror:8 row_mask:0xf bank_mask:0xf
    v_add_f32_dpp v66, v66, v66 row_ror:8 row_mask:0xf bank_mask:0xf
    s_nop 0
    v_add_f32_dpp v64, v64, v64 row_ror:4 row_mask:0xf bank_mask:0xf
    v_add_f32_dpp v66, v66, v66 row_ror:4 row_mask:0xf bank_mask:0xf
    s_nop 0
    v_add_f32_dpp v64, v64, v64 row_ror:2 row_mask:0xf bank_mask:0xf
    v_add_f32_dpp v66, v66, v66 row_ror:2 row_mask:0xf bank_mask:0xf
    s_nop 0
    v_add_f32_dpp v64, v64, v64 row_ror:1 row_mask:0xf bank_mask:0xf
    v_add_f32_dpp v66, v66, v66 row_ror:1 row_mask:0xf bank_mask:0xf
    v_mul_f32 v64, 0x3a800000, v64
    v_mul_f32 v66, 0x3a800000, v66
    v_fma_f32 v66, -v64, v64, v66
    v_max_f32 v66, 0, v66
    v_add_f32 v66, 0x3727c5ac, v66
    v_rsq_f32 v66, v66
    v_add_f32 v64, v64, v72
    v_mul_f32 v66, 0x3eeff558, v66
    v_mul_f32 v67, v64, v66
    v_sub_f32 v67, 0, v67
    v_lshrrev_b32 v65, 5, v2
    v_lshlrev_b32 v65, 3, v65
    s_lshl_b32 s58, s62, 4
    s_add_u32 s58, s58, 131072
    v_add_u32 v65, s58, v65
    ds_write_b64 v65, v[66:67]
    s_waitcnt lgkmcnt(0)
    s_mul_i32 s20, s20, 0x9e3779b1
    s_add_u32 s20, s20, 0x7f4a7c15
    s_barrier
    s_cmp_ge_u32 s2, 224
    s_cbranch_scc1 L_l_spare
    s_mov_b32 s28, s6
    s_mov_b32 s29, s7
    s_mov_b32 s30, 14680064
    s_mov_b32 s31, 0x20000
    s_mov_b32 s48, 7168
    s_lshl_b32 s49, s62, 4
    s_lshl_b32 s50, s23, 8
    v_add_u32 v6, 0, v3
    v_xor_b32 v6, v6, v5
    v_lshl_add_u32 v6, v6, 5, v4
    s_add_u32 s51, s49, 0
    v_add_u32 v7, s51, v3
    v_mul_lo_u32 v7, v7, s48
    v_add3_u32 v8, v7, v6, s50
    v_add_u32 v6, 4, v3
    v_xor_b32 v6, v6, v5
    v_lshl_add_u32 v6, v6, 5, v4
    s_add_u32 s51, s49, 4
    v_add_u32 v7, s51, v3
    v_mul_lo_u32 v7, v7, s48
    v_add3_u32 v9, v7, v6, s50
    v_subrev_u32 v9, 1024, v9
    v_add_u32 v6, 0, v3
    v_xor_b32 v6, v6, v5
    v_lshl_add_u32 v6, v6, 5, v4
    s_add_u32 s51, s49, 8
    v_add_u32 v7, s51, v3
    v_mul_lo_u32 v7, v7, s48
    v_add3_u32 v10, v7, v6, s50
    v_subrev_u32 v10, 2048, v10
    v_add_u32 v6, 4, v3
    v_xor_b32 v6, v6, v5
    v_lshl_add_u32 v6, v6, 5, v4
    s_add_u32 s51, s49, 12
    v_add_u32 v7, s51, v3
    v_mul_lo_u32 v7, v7, s48
    v_add3_u32 v11, v7, v6, s50
    v_subrev_u32 v11, 3072, v11
    s_mov_b32 s64, s6
    s_mov_b32 s65, s7
    s_mul_i32 s48, s24, 532480
    s_add_u32 s48, s48, s52
    v_lshl_add_u32 v12, v2, 4, s48
    v_and_b32 v26, 31, v2
    v_lshl_add_u32 v26, v26, 7, s48
    v_lshrrev_b32 v27, 5, v2
    v_lshl_add_u32 v26, v27, 14, v26
    s_add_u32 s66, s18, 0
    s_addc_u32 s67, s19, 0
    s_barrier
    s_cmp_lt_u32 s2, 64
    s_cbranch_scc1 L_l_wlate
    s_add_u32 m0, s52, 0
    s_nop 0
    global_load_lds_dwordx4 v8, s[64:65] offset:0
    global_load_lds_dwordx4 v9, s[64:65] offset:1024
    global_load_lds_dwordx4 v10, s[64:65] offset:2048
    global_load_lds_dwordx4 v11, s[64:65] offset:3072
    s_add_u32 s64, s64, 458752
    s_addc_u32 s65, s65, 0
    s_add_u32 m0, s52, 32768
    s_nop 0
    global_load_lds_dwordx4 v8, s[64:65] offset:0
    global_load_lds_dwordx4 v9, s[64:65] offset:1024
    global_load_lds_dwordx4 v10, s[64:65] offset:2048
    global_load_lds_dwordx4 v11, s[64:65] offset:3072
    s_add_u32 s64, s64, 458752
    s_addc_u32 s65, s65, 0
    s_add_u32 m0, s52, 65536
    s_nop 0
    global_load_lds_dwordx4 v8, s[64:65] offset:0
    global_load_lds_dwordx4 v9, s[64:65] offset:1024
    global_load_lds_dwordx4 v10, s[64:65] offset:2048
    global_load_lds_dwordx4 v11, s[64:65] offset:3072
    s_add_u32 s64, s64, 458752
    s_addc_u32 s65, s65, 0
    s_add_u32 m0, s52, 98304
    s_nop 0
    global_load_lds_dwordx4 v8, s[64:65] offset:0
    global_load_lds_dwordx4 v9, s[64:65] offset:1024
    global_load_lds_dwordx4 v10, s[64:65] offset:2048
    global_load_lds_dwordx4 v11, s[64:65] offset:3072
    s_add_u32 s64, s64, 458752
    s_addc_u32 s65, s65, 0
    s_barrier
    s_branch L_l_wdone
L_l_wlate:
    s_barrier
    s_add_u32 m0, s52, 0
    s_nop 0
    global_load_lds_dwordx4 v8, s[64:65] offset:0
    global_load_lds_dwordx4 v9, s[64:65] offset:1024
    global_load_lds_dwordx4 v10, s[64:65] offset:2048
    global_load_lds_dwordx4 v11, s[64:65] offset:3072
    s_add_u32 s64, s64, 458752
    s_addc_u32 s65, s65, 0
    s_add_u32 m0, s52, 32768
    s_nop 0
    global_load_lds_dwordx4 v8, s[64:65] offset:0
    global_load_lds_dwordx4 v9, s[64:65] offset:1024
    global_load_lds_dwordx4 v10, s[64:65] offset:2048
    global_load_lds_dwordx4 v11, s[64:65] offset:3072
    s_add_u32 s64, s64, 458752
    s_addc_u32 s65, s65, 0
    s_add_u32 m0, s52, 65536
    s_nop 0
    global_load_lds_dwordx4 v8, s[64:65] offset:0
    global_load_lds_dwordx4 v9, s[64:65] offset:1024
    global_load_lds_dwordx4 v10, s[64:65] offset:2048
    global_load_lds_dwordx4 v11, s[64:65] offset:3072
    s_add_u32 s64, s64, 458752
    s_addc_u32 s65, s65, 0
    s_add_u32 m0, s52, 98304
    s_nop 0
    global_load_lds_dwordx4 v8, s[64:65] offset:0
    global_load_lds_dwordx4 v9, s[64:65] offset:1024
    global_load_lds_dwordx4 v10, s[64:65] offset:2048
    global_load_lds_dwordx4 v11, s[64:65] offset:3072
    s_add_u32 s64, s64, 458752
    s_addc_u32 s65, s65, 0
L_l_wdone:
    global_load_dword v31, v26, s[66:67] sc1
    s_mov_b32 s57, 0xff
    s_mov_b32 s63, 0xff
    s_cmp_lg_u32 s3, 4
    s_cbranch_scc1 L_l_s1seen
    s_mov_b32 s59, 0x80000
    s_mov_b64 exec, 65535
L_l_p1:
    buffer_load_dwordx4 v[16:19], v13, s[36:39], s56 offen sc1
    s_sub_u32 s59, s59, 1
    s_cbranch_scc1 L_l_p1_x
    s_waitcnt vmcnt(0)
L_l_p1_c:
    v_cmp_ne_u32 vcc, s20, v16
    v_cmp_ne_u32 s[60:61], s20, v17
    s_or_b64 vcc, vcc, s[60:61]
    v_cmp_ne_u32 s[60:61], s20, v18
    s_or_b64 vcc, vcc, s[60:61]
    v_cmp_ne_u32 s[60:61], s20, v19
    s_or_b64 vcc, vcc, s[60:61]
    s_cmp_lg_u64 vcc, 0
    s_cbranch_scc1 L_l_p1
L_l_p1_x:
    s_mov_b64 exec, -1
    s_mov_b32 s57, 4
    s_mov_b32 s63, 2
L_l_s1seen:
    s_barrier
    s_add_u32 m0, s52, 16384
    s_nop 0
    global_load_lds_dwordx4 v12, s[66:67] offset:0 sc1
    global_load_lds_dwordx4 v12, s[66:67] offset:1024 sc1
    global_load_lds_dwordx4 v12, s[66:67] offset:2048 sc1
    global_load_lds_dwordx4 v12, s[66:67] offset:3072 sc1
    s_add_u32 s66, s66, 16384
    s_addc_u32 s67, s67, 0
    s_add_u32 m0, s52, 49152
    s_nop 0
    global_load_lds_dwordx4 v12, s[66:67] offset:0 sc1
    global_load_lds_dwordx4 v12, s[66:67] offset:1024 sc1
    global_load_lds_dwordx4 v12, s[66:67] offset:2048 sc1
    global_load_lds_dwordx4 v12, s[66:67] offset:3072 sc1
    s_add_u32 s66, s66, 16384
    s_addc_u32 s67, s67, 0
    s_add_u32 m0, s52, 81920
    s_nop 0
    global_load_lds_dwordx4 v12, s[66:67] offset:0 sc1
    global_load_lds_dwordx4 v12, s[66:67] offset:1024 sc1
    global_load_lds_dwordx4 v12, s[66:67] offset:2048 sc1
    global_load_lds_dwordx4 v12, s[66:67] offset:3072 sc1
    s_add_u32 s66, s66, 16384
    s_addc_u32 s67, s67, 0
    s_add_u32 m0, s52, 114688
    s_nop 0
    global_load_lds_dwordx4 v12, s[66:67] offset:0 sc1
    global_load_lds_dwordx4 v12, s[66:67] offset:1024 sc1
    global_load_lds_dwordx4 v12, s[66:67] offset:2048 sc1
    global_load_lds_dwordx4 v12, s[66:67] offset:3072 sc1
    s_add_u32 s66, s66, 16384
    s_addc_u32 s67, s67, 0
    s_waitcnt vmcnt(12)
    s_barrier
    s_waitcnt vmcnt(8)
    s_barrier
    s_add_u32 m0, s52, 0
    s_nop 0
    global_load_lds_dwordx4 v8, s[64:65] offset:0
    global_load_lds_dwordx4 v9, s[64:65] offset:1024
    global_load_lds_dwordx4 v10, s[64:65] offset:2048
    global_load_lds_dwordx4 v11, s[64:65] offset:3072
    s_add_u32 s64, s64, 458752
    s_addc_u32 s65, s65, 0
    s_add_u32 m0, m0, 16384
    s_nop 0
    global_load_lds_dwordx4 v12, s[66:67] offset:0 sc1
    global_load_lds_dwordx4 v12, s[66:67] offset:1024 sc1
    global_load_lds_dwordx4 v12, s[66:67] offset:2048 sc1
    global_load_lds_dwordx4 v12, s[66:67] offset:3072 sc1
    s_add_u32 s66, s66, 16384
    s_addc_u32 s67, s67, 0
    s_waitcnt vmcnt(12)
    s_barrier
    s_add_u32 m0, s52, 32768
    s_nop 0
    global_load_lds_dwordx4 v8, s[64:65] offset:0
    global_load_lds_dwordx4 v9, s[64:65] offset:1024
    global_load_lds_dwordx4 v10, s[64:65] offset:2048
    global_load_lds_dwordx4 v11, s[64:65] offset:3072
    s_add_u32 s64, s64, 458752
    s_addc_u32 s65, s65, 0
    s_add_u32 m0, m0, 16384
    s_nop 0
    global_load_lds_dwordx4 v12, s[66:67] offset:0 sc1
    global_load_lds_dwordx4 v12, s[66:67] offset:1024 sc1
    global_load_lds_dwordx4 v12, s[66:67] offset:2048 sc1
    global_load_lds_dwordx4 v12, s[66:67] offset:3072 sc1
    s_add_u32 s66, s66, 16384
    s_addc_u32 s67, s67, 0
    s_mov_b32 s53, 2
.p2align 6
L_l_loop1:
    s_and_b32 s54, s53, 3
    s_lshl_b32 s54, s54, 15
    s_waitcnt vmcnt(16)
    s_cmp_lg_u32 s53, s57
    s_cbranch_scc1 L_l_nochk1
    s_mov_b32 s59, 0x80000
    s_waitcnt vmcnt(16)
    s_branch L_l_p1b_c
L_l_p1b:
    buffer_load_dwordx4 v[16:19], v13, s[36:39], s56 offen sc1
    s_sub_u32 s59, s59, 1
    s_cbranch_scc1 L_l_p1b_x
    s_waitcnt vmcnt(0)
L_l_p1b_c:
    v_cmp_ne_u32 vcc, s20, v16
    v_cmp_ne_u32 s[60:61], s20, v17
    s_or_b64 vcc, vcc, s[60:61]
    v_cmp_ne_u32 s[60:61], s20, v18
    s_or_b64 vcc, vcc, s[60:61]
    v_cmp_ne_u32 s[60:61], s20, v19
    s_or_b64 vcc, vcc, s[60:61]
    s_cmp_lg_u64 vcc, 0
    s_cbranch_scc1 L_l_p1b
L_l_p1b_x:
    s_cmp_lg_u32 s2, 0
    s_cbranch_scc1 L_l_nochk1
    v_mov_b32 v16, s20
    v_mov_b32 v17, 0
    s_mov_b64 exec, 1
    buffer_store_dword v16, v17, s[36:39], 0 offen offset:0 sc1
    s_mov_b64 exec, -1
L_l_nochk1:
    s_barrier
    s_cmp_lg_u32 s53, s63
    s_cbranch_scc1 L_l_noiss1
    buffer_load_dwordx4 v[16:19], v13, s[36:39], s56 offen sc1
L_l_noiss1:
    s_add_u32 m0, s52, s54
    s_nop 0
    global_load_lds_dwordx4 v8, s[64:65] offset:0
    global_load_lds_dwordx4 v9, s[64:65] offset:1024
    global_load_lds_dwordx4 v10, s[64:65] offset:2048
    global_load_lds_dwordx4 v11, s[64:65] offset:3072
    s_add_u32 s64, s64, 458752
    s_addc_u32 s65, s65, 0
    s_add_u32 m0, m0, 16384
    s_nop 0
    global_load_lds_dwordx4 v12, s[66:67] offset:0 sc1
    global_load_lds_dwordx4 v12, s[66:67] offset:1024 sc1
    global_load_lds_dwordx4 v12, s[66:67] offset:2048 sc1
    global_load_lds_dwordx4 v12, s[66:67] offset:3072 sc1
    s_add_u32 s66, s66, 16384
    s_addc_u32 s67, s67, 0
    s_add_u32 s53, s53, 1
    s_cmp_lt_u32 s53, 28
    s_cbranch_scc1 L_l_loop1
    s_mov_b32 s28, s10
    s_mov_b32 s29, s11
    s_mov_b32 s30, 14680064
    s_mov_b32 s31, 0x20000
    s_mov_b32 s48, 4096
    s_lshl_b32 s49, s62, 4
    s_lshl_b32 s50, s25, 8
    s_and_b32 s51, s49, 32
    s_add_u32 s49, s49, s51
    v_add_u32 v6, 0, v3
    v_xor_b32 v6, v6, v5
    v_lshl_add_u32 v6, v6, 5, v4
    s_add_u32 s51, s49, 0
    v_add_u32 v7, s51, v3
    v_mul_lo_u32 v7, v7, s48
    v_add3_u32 v8, v7, v6, s50
    v_add_u32 v6, 4, v3
    v_xor_b32 v6, v6, v5
    v_lshl_add_u32 v6, v6, 5, v4
    s_add_u32 s51, s49, 4
    v_add_u32 v7, s51, v3
    v_mul_lo_u32 v7, v7, s48
    v_add3_u32 v9, v7, v6, s50
    v_subrev_u32 v9, 1024, v9
    v_add_u32 v6, 0, v3
    v_xor_b32 v6, v6, v5
    v_lshl_add_u32 v6, v6, 5, v4
    s_add_u32 s51, s49, 8
    v_add_u32 v7, s51, v3
    v_mul_lo_u32 v7, v7, s48
    v_add3_u32 v10, v7, v6, s50
    v_subrev_u32 v10, 2048, v10
    v_add_u32 v6, 4, v3
    v_xor_b32 v6, v6, v5
    v_lshl_add_u32 v6, v6, 5, v4
    s_add_u32 s51, s49, 12
    v_add_u32 v7, s51, v3
    v_mul_lo_u32 v7, v7, s48
    v_add3_u32 v11, v7, v6, s50
    v_subrev_u32 v11, 3072, v11
    s_mul_i32 s50, s27, 7340032
    s_add_u32 s64, s10, s50
    s_addc_u32 s65, s11, 0
    s_waitcnt vmcnt(16)
    s_barrier
    s_add_u32 m0, s52, 0
    s_nop 0
    global_load_lds_dwordx4 v8, s[64:65] offset:0
    global_load_lds_dwordx4 v9, s[64:65] offset:1024
    global_load_lds_dwordx4 v10, s[64:65] offset:2048
    global_load_lds_dwordx4 v11, s[64:65] offset:3072
    s_add_u32 s64, s64, 524288
    s_addc_u32 s65, s65, 0
    s_waitcnt vmcnt(12)
    s_barrier
    s_add_u32 m0, s52, 32768
    s_nop 0
    global_load_lds_dwordx4 v8, s[64:65] offset:0
    global_load_lds_dwordx4 v9, s[64:65] offset:1024
    global_load_lds_dwordx4 v10, s[64:65] offset:2048
    global_load_lds_dwordx4 v11, s[64:65] offset:3072
    s_add_u32 s64, s64, 524288
    s_addc_u32 s65, s65, 0
    s_waitcnt vmcnt(8)
    s_barrier
    s_add_u32 m0, s52, 65536
    s_nop 0
    global_load_lds_dwordx4 v8, s[64:65] offset:0
    global_load_lds_dwordx4 v9, s[64:65] offset:1024
    global_load_lds_dwordx4 v10, s[64:65] offset:2048
    global_load_lds_dwordx4 v11, s[64:65] offset:3072
    s_add_u32 s64, s64, 524288
    s_addc_u32 s65, s65, 0
    s_barrier
    s_add_u32 m0, s52, 98304
    s_nop 0
    global_load_lds_dwordx4 v8, s[64:65] offset:0
    global_load_lds_dwordx4 v9, s[64:65] offset:1024
    global_load_lds_dwordx4 v10, s[64:65] offset:2048
    global_load_lds_dwordx4 v11, s[64:65] offset:3072
    s_add_u32 s64, s64, 524288
    s_addc_u32 s65, s65, 0
L_l_g2:
    s_mul_i32 s48, s26, 925696
    s_add_u32 s48, s48, s52
    v_lshl_add_u32 v12, v2, 4, s48
    v_and_b32 v26, 31, v2
    v_lshl_add_u32 v26, v26, 7, s48
    v_lshrrev_b32 v27, 5, v2
    v_lshl_add_u32 v26, v27, 14, v26
    s_mul_i32 s51, s27, 458752
    s_add_u32 s51, s51, 6291456
    s_add_u32 s66, s18, s51
    s_addc_u32 s67, s19, 0
    s_mov_b32 s44, s14
    s_mov_b32 s45, s15
    s_mov_b32 s46, 4194304
    s_mov_b32 s47, 0x20000
    s_lshl_b32 s58, s25, 7
    s_lshr_b32 s59, s62, 1
    s_lshl_b32 s59, s59, 6
    s_add_u32 s58, s58, s59
    s_lshl_b32 s59, s27, 5
    s_add_u32 s58, s58, s59
    s_lshl_b32 s58, s58, 11
    s_lshl_b32 s59, s26, 8
    s_add_u32 s58, s58, s59
    s_and_b32 s59, s62, 1
    s_lshl_b32 s59, s59, 7
    s_add_u32 s58, s58, s59
    v_lshl_add_u32 v23, v2, 11, s58
    s_lshl_b32 s58, s2, 10
    s_lshl_b32 s59, s62, 8
    s_add_u32 s58, s58, s59
    s_add_u32 s58, s58, 393216
    v_mov_b32 v24, s58
    s_mul_i32 s48, s22, 28
    s_mul_i32 s49, s62, 7
    s_add_u32 s49, s49, s48
    s_lshr_b32 s58, s21, 2
    s_add_u32 s58, s58, 32
    s_and_b32 s59, s21, 3
    s_lshl_b32 s59, s59, 10
    v_and_b32 v29, 7, v2
    v_lshl_add_u32 v29, v29, 7, s59
    v_lshrrev_b32 v6, 3, v2
    v_cmp_gt_u32 vcc, 7, v6
    v_add_u32 v6, s49, v6
    v_and_b32 v7, 1, v6
    v_mul_u32_u24 v7, 1792, v7
    v_and_b32 v6, -2, v6
    v_add3_u32 v7, v7, v6, s58
    v_and_b32 v6, 0xffffffe0, v6
    v_add_u32 v7, v7, v6
    v_lshl_add_u32 v29, v7, 12, v29
    v_mov_b32 v6, 2147483647
    v_cndmask_b32 v29, v6, v29, vcc
    s_lshr_b32 s55, s22, 1
    s_add_u32 s55, s55, 2
    s_lshl_b32 s56, s26, 1
    s_add_u32 s56, s56, s27
    s_lshl_b32 s56, s56, 12
    s_add_u32 s56, s56, 131072
    v_lshlrev_b32 v13, 7, v2
    s_cmp_ge_u32 s2, 224
    s_cbranch_scc1 L_l_nob4
    s_barrier
L_l_nob4:
    s_mov_b32 s57, 0xff
    s_mov_b32 s63, 0xff
    s_cmp_lg_u32 s3, 4
    s_cbranch_scc1 L_l_s2seen
    s_mov_b32 s59, 0x80000
    s_mov_b64 exec, 16383
L_l_p2:
    buffer_load_dwordx4 v[16:19], v13, s[36:39], s56 offen sc1
    s_sub_u32 s59, s59, 1
    s_cbranch_scc1 L_l_p2_x
    s_waitcnt vmcnt(0)
L_l_p2_c:
    v_cmp_ne_u32 vcc, s20, v16
    v_cmp_ne_u32 s[60:61], s20, v17
    s_or_b64 vcc, vcc, s[60:61]
    v_cmp_ne_u32 s[60:61], s20, v18
    s_or_b64 vcc, vcc, s[60:61]
    v_cmp_ne_u32 s[60:61], s20, v19
    s_or_b64 vcc, vcc, s[60:61]
    s_cmp_lg_u64 vcc, 0
    s_cbranch_scc1 L_l_p2
L_l_p2_x:
    s_mov_b64 exec, -1
    s_mov_b32 s57, 10
    s_mov_b32 s63, 8
    s_add_u32 s56, s56, 2048
L_l_s2seen:
    s_barrier
    s_add_u32 m0, s52, 16384
    s_nop 0
    global_load_lds_dwordx4 v12, s[66:67] offset:0 sc1
    global_load_lds_dwordx4 v12, s[66:67] offset:1024 sc1
    global_load_lds_dwordx4 v12, s[66:67] offset:2048 sc1
    global_load_lds_dwordx4 v12, s[66:67] offset:3072 sc1
    s_add_u32 s66, s66, 16384
    s_addc_u32 s67, s67, 0
    s_add_u32 m0, s52, 49152
    s_nop 0
    global_load_lds_dwordx4 v12, s[66:67] offset:0 sc1
    global_load_lds_dwordx4 v12, s[66:67] offset:1024 sc1
    global_load_lds_dwordx4 v12, s[66:67] offset:2048 sc1
    global_load_lds_dwordx4 v12, s[66:67] offset:3072 sc1
    s_add_u32 s66, s66, 16384
    s_addc_u32 s67, s67, 0
    s_add_u32 m0, s52, 81920
    s_nop 0
    global_load_lds_dwordx4 v12, s[66:67] offset:0 sc1
    global_load_lds_dwordx4 v12, s[66:67] offset:1024 sc1
    global_load_lds_dwordx4 v12, s[66:67] offset:2048 sc1
    global_load_lds_dwordx4 v12, s[66:67] offset:3072 sc1
    s_add_u32 s66, s66, 16384
    s_addc_u32 s67, s67, 0
    s_add_u32 m0, s52, 114688
    s_nop 0
    global_load_lds_dwordx4 v12, s[66:67] offset:0 sc1
    global_load_lds_dwordx4 v12, s[66:67] offset:1024 sc1
    global_load_lds_dwordx4 v12, s[66:67] offset:2048 sc1
    global_load_lds_dwordx4 v12, s[66:67] offset:3072 sc1
    s_add_u32 s66, s66, 16384
    s_addc_u32 s67, s67, 0
    s_waitcnt vmcnt(12)
    s_barrier
    s_waitcnt vmcnt(8)
    s_barrier
    s_add_u32 m0, s52, 0
    s_nop 0
    global_load_lds_dwordx4 v8, s[64:65] offset:0
    global_load_lds_dwordx4 v9, s[64:65] offset:1024
    global_load_lds_dwordx4 v10, s[64:65] offset:2048
    global_load_lds_dwordx4 v11, s[64:65] offset:3072
    s_add_u32 s64, s64, 524288
    s_addc_u32 s65, s65, 0
    s_add_u32 m0, m0, 16384
    s_nop 0
    global_load_lds_dwordx4 v12, s[66:67] offset:0 sc1
    global_load_lds_dwordx4 v12, s[66:67] offset:1024 sc1
    global_load_lds_dwordx4 v12, s[66:67] offset:2048 sc1
    global_load_lds_dwordx4 v12, s[66:67] offset:3072 sc1
    s_add_u32 s66, s66, 16384
    s_addc_u32 s67, s67, 0
    s_waitcnt vmcnt(12)
    s_barrier
    s_add_u32 m0, s52, 32768
    s_nop 0
    global_load_lds_dwordx4 v8, s[64:65] offset:0
    global_load_lds_dwordx4 v9, s[64:65] offset:1024
    global_load_lds_dwordx4 v10, s[64:65] offset:2048
    global_load_lds_dwordx4 v11, s[64:65] offset:3072
    s_add_u32 s64, s64, 524288
    s_addc_u32 s65, s65, 0
    s_add_u32 m0, m0, 16384
    s_nop 0
    global_load_lds_dwordx4 v12, s[66:67] offset:0 sc1
    global_load_lds_dwordx4 v12, s[66:67] offset:1024 sc1
    global_load_lds_dwordx4 v12, s[66:67] offset:2048 sc1
    global_load_lds_dwordx4 v12, s[66:67] offset:3072 sc1
    s_add_u32 s66, s66, 16384
    s_addc_u32 s67, s67, 0
    s_mov_b32 s53, 2
.p2align 6
L_l_loop2:
    s_and_b32 s54, s53, 3
    s_lshl_b32 s54, s54, 15
    s_waitcnt vmcnt(16)
    s_cmp_lg_u32 s53, s57
    s_cbranch_scc1 L_l_nochk2
    s_mov_b32 s59, 0x80000
    s_mov_b64 exec, 16383
    s_waitcnt vmcnt(16)
    s_branch L_l_p2b_c
L_l_p2b:
    buffer_load_dwordx4 v[16:19], v13, s[36:39], s56 offen sc1
    s_sub_u32 s59, s59, 1
    s_cbranch_scc1 L_l_p2b_x
    s_waitcnt vmcnt(0)
L_l_p2b_c:
    v_cmp_ne_u32 vcc, s20, v16
    v_cmp_ne_u32 s[60:61], s20, v17
    s_or_b64 vcc, vcc, s[60:61]
    v_cmp_ne_u32 s[60:61], s20, v18
    s_or_b64 vcc, vcc, s[60:61]
    v_cmp_ne_u32 s[60:61], s20, v19
    s_or_b64 vcc, vcc, s[60:61]
    s_cmp_lg_u64 vcc, 0
    s_cbranch_scc1 L_l_p2b
L_l_p2b_x:
    s_mov_b64 exec, -1
L_l_nochk2:
    s_barrier
    s_cmp_lg_u32 s53, s63
    s_cbranch_scc1 L_l_noiss2
    s_mov_b64 exec, 16383
    buffer_load_dwordx4 v[16:19], v13, s[36:39], s56 offen sc1
    s_mov_b64 exec, -1
L_l_noiss2:
    s_add_u32 m0, s52, s54
    s_nop 0
    global_load_lds_dwordx4 v8, s[64:65] offset:0
    global_load_lds_dwordx4 v9, s[64:65] offset:1024
    global_load_lds_dwordx4 v10, s[64:65] offset:2048
    global_load_lds_dwordx4 v11, s[64:65] offset:3072
    s_add_u32 s64, s64, 524288
    s_addc_u32 s65, s65, 0
    s_add_u32 m0, m0, 16384
    s_nop 0
    global_load_lds_dwordx4 v12, s[66:67] offset:0 sc1
    global_load_lds_dwordx4 v12, s[66:67] offset:1024 sc1
    global_load_lds_dwordx4 v12, s[66:67] offset:2048 sc1
    global_load_lds_dwordx4 v12, s[66:67] offset:3072 sc1
    s_add_u32 s66, s66, 16384
    s_addc_u32 s67, s67, 0
    s_cmp_eq_u32 s53, 9
    s_cselect_b32 s58, 7208960, 0
    s_sub_u32 s64, s64, s58
    s_subb_u32 s65, s65, 0
    s_cmp_lg_u32 s53, s55
    s_cbranch_scc1 L_l_nolate
    buffer_load_dword v31, v29, s[28:31], 0 offen
L_l_nolate:
    s_add_u32 s53, s53, 1
    s_cmp_lt_u32 s53, 20
    s_cbranch_scc1 L_l_loop2
    s_waitcnt vmcnt(16)
    s_barrier
.p2align 6
L_l_loopb:
    s_and_b32 s54, s53, 3
    s_lshl_b32 s54, s54, 15
    s_waitcnt vmcnt(8)
    s_barrier
    s_add_u32 m0, s52, s54
    s_nop 0
    global_load_lds_dwordx4 v8, s[64:65] offset:0
    global_load_lds_dwordx4 v9, s[64:65] offset:1024
    global_load_lds_dwordx4 v10, s[64:65] offset:2048
    global_load_lds_dwordx4 v11, s[64:65] offset:3072
    s_add_u32 s64, s64, 524288
    s_addc_u32 s65, s65, 0
    s_add_u32 m0, m0, 16384
    s_nop 0
    global_load_lds_dwordx4 v12, s[66:67] offset:0 sc1
    global_load_lds_dwordx4 v12, s[66:67] offset:1024 sc1
    global_load_lds_dwordx4 v12, s[66:67] offset:2048 sc1
    global_load_lds_dwordx4 v12, s[66:67] offset:3072 sc1
    s_add_u32 s66, s66, 16384
    s_addc_u32 s67, s67, 0
    s_add_u32 s53, s53, 1
    s_cmp_lt_u32 s53, 24
    s_cbranch_scc1 L_l_loopb
    s_mov_b32 exec_hi, 0
    buffer_load_dword v31, v23, s[44:47], 0 offen sc1
    s_mov_b64 exec, 1
    buffer_load_dword v31, v24, s[36:39], 0 offen sc1
    s_mov_b64 exec, -1
    s_waitcnt vmcnt(10)
    s_barrier
    s_waitcnt vmcnt(2)
    s_barrier
    s_barrier
    s_endpgm
L_l_spare:
    s_mov_b32 s28, s10
    s_mov_b32 s29, s11
    s_mov_b32 s30, 14680064
    s_mov_b32 s31, 0x20000
    s_mov_b32 s48, 4096
    s_lshl_b32 s49, s62, 4
    s_lshl_b32 s50, s25, 8
    s_and_b32 s51, s49, 32
    s_add_u32 s49, s49, s51
    v_add_u32 v6, 0, v3
    v_xor_b32 v6, v6, v5
    v_lshl_add_u32 v6, v6, 5, v4
    s_add_u32 s51, s49, 0
    v_add_u32 v7, s51, v3
    v_mul_lo_u32 v7, v7, s48
    v_add3_u32 v8, v7, v6, s50
    v_add_u32 v6, 4, v3
    v_xor_b32 v6, v6, v5
    v_lshl_add_u32 v6, v6, 5, v4
    s_add_u32 s51, s49, 4
    v_add_u32 v7, s51, v3
    v_mul_lo_u32 v7, v7, s48
    v_add3_u32 v9, v7, v6, s50
    v_subrev_u32 v9, 1024, v9
    v_add_u32 v6, 0, v3
    v_xor_b32 v6, v6, v5
    v_lshl_add_u32 v6, v6, 5, v4
    s_add_u32 s51, s49, 8
    v_add_u32 v7, s51, v3
    v_mul_lo_u32 v7, v7, s48
    v_add3_u32 v10, v7, v6, s50
    v_subrev_u32 v10, 2048, v10
    v_add_u32 v6, 4, v3
    v_xor_b32 v6, v6, v5
    v_lshl_add_u32 v6, v6, 5, v4
    s_add_u32 s51, s49, 12
    v_add_u32 v7, s51, v3
    v_mul_lo_u32 v7, v7, s48
    v_add3_u32 v11, v7, v6, s50
    v_subrev_u32 v11, 3072, v11
    s_mul_i32 s50, s27, 7340032
    s_add_u32 s64, s10, s50
    s_addc_u32 s65, s11, 0
    s_barrier
    s_barrier
    s_cmp_lg_u32 s3, 4
    s_cbranch_scc1 L_l_spw
    s_sub_u32 s48, s2, 224
    v_and_b32 v14, 31, v2
    v_lshlrev_b32 v14, 7, v14
    v_lshrrev_b32 v7, 5, v2
    v_mul_u32_u24 v7, 1792, v7
    v_add_u32 v7, s48, v7
    v_lshl_add_u32 v14, v7, 12, v14
    s_mov_b32 s48, 0
L_l_sp0:
    buffer_load_dword v31, v14, s[28:31], s48 offen
    s_add_u32 s48, s48, 262144
    s_cmp_lt_u32 s48, 2097152
    s_cbranch_scc1 L_l_sp0
    s_add_u32 s48, s22, 36
    s_mul_i32 s48, s48, 43008
L_l_sp1:
    buffer_load_dword v31, v25, s[32:35], s48 offen
    s_add_u32 s48, s48, 172032
    s_cmp_lt_u32 s48, 14680064
    s_cbranch_scc1 L_l_sp1
    s_add_u32 m0, s52, 0
    s_nop 0
    global_load_lds_dwordx4 v8, s[64:65] offset:0
    global_load_lds_dwordx4 v9, s[64:65] offset:1024
    global_load_lds_dwordx4 v10, s[64:65] offset:2048
    global_load_lds_dwordx4 v11, s[64:65] offset:3072
    s_add_u32 s64, s64, 524288
    s_addc_u32 s65, s65, 0
    s_add_u32 m0, s52, 32768
    s_nop 0
    global_load_lds_dwordx4 v8, s[64:65] offset:0
    global_load_lds_dwordx4 v9, s[64:65] offset:1024
    global_load_lds_dwordx4 v10, s[64:65] offset:2048
    global_load_lds_dwordx4 v11, s[64:65] offset:3072
    s_add_u32 s64, s64, 524288
    s_addc_u32 s65, s65, 0
    s_add_u32 m0, s52, 65536
    s_nop 0
    global_load_lds_dwordx4 v8, s[64:65] offset:0
    global_load_lds_dwordx4 v9, s[64:65] offset:1024
    global_load_lds_dwordx4 v10, s[64:65] offset:2048
    global_load_lds_dwordx4 v11, s[64:65] offset:3072
    s_add_u32 s64, s64, 524288
    s_addc_u32 s65, s65, 0
    s_add_u32 m0, s52, 98304
    s_nop 0
    global_load_lds_dwordx4 v8, s[64:65] offset:0
    global_load_lds_dwordx4 v9, s[64:65] offset:1024
    global_load_lds_dwordx4 v10, s[64:65] offset:2048
    global_load_lds_dwordx4 v11, s[64:65] offset:3072
    s_add_u32 s64, s64, 524288
    s_addc_u32 s65, s65, 0
    s_sub_u32 s48, s22, 28
    s_lshl_b32 s48, s48, 3
    s_lshr_b32 s58, s21, 2
    s_add_u32 s58, s58, 0
    s_and_b32 s59, s21, 3
    s_lshl_b32 s59, s59, 10
    v_and_b32 v14, 7, v2
    v_lshl_add_u32 v14, v14, 7, s59
    v_lshrrev_b32 v6, 3, v2
    v_cmp_gt_u32 vcc, 8, v6
    v_add_u32 v6, s48, v6
    v_and_b32 v7, 1, v6
    v_mul_u32_u24 v7, 1792, v7
    v_and_b32 v6, -2, v6
    v_add3_u32 v7, v7, v6, s58
    v_lshl_add_u32 v14, v7, 12, v14
    v_mov_b32 v6, 2147483647
    v_cndmask_b32 v14, v6, v14, vcc
    s_mov_b32 s48, 2097152
L_l_sp2:
    buffer_load_dword v31, v14, s[28:31], s48 offen
    s_add_u32 s48, s48, 262144
    s_cmp_lt_u32 s48, 7340032
    s_cbranch_scc1 L_l_sp2
    s_branch L_l_g2
L_l_spw:
    s_add_u32 m0, s52, 0
    s_nop 0
    global_load_lds_dwordx4 v8, s[64:65] offset:0
    global_load_lds_dwordx4 v9, s[64:65] offset:1024
    global_load_lds_dwordx4 v10, s[64:65] offset:2048
    global_load_lds_dwordx4 v11, s[64:65] offset:3072
    s_add_u32 s64, s64, 524288
    s_addc_u32 s65, s65, 0
    s_add_u32 m0, s52, 32768
    s_nop 0
    global_load_lds_dwordx4 v8, s[64:65] offset:0
    global_load_lds_dwordx4 v9, s[64:65] offset:1024
    global_load_lds_dwordx4 v10, s[64:65] offset:2048
    global_load_lds_dwordx4 v11, s[64:65] offset:3072
    s_add_u32 s64, s64, 524288
    s_addc_u32 s65, s65, 0
    s_add_u32 m0, s52, 65536
    s_nop 0
    global_load_lds_dwordx4 v8, s[64:65] offset:0
    global_load_lds_dwordx4 v9, s[64:65] offset:1024
    global_load_lds_dwordx4 v10, s[64:65] offset:2048
    global_load_lds_dwordx4 v11, s[64:65] offset:3072
    s_add_u32 s64, s64, 524288
    s_addc_u32 s65, s65, 0
    s_add_u32 m0, s52, 98304
    s_nop 0
    global_load_lds_dwordx4 v8, s[64:65] offset:0
    global_load_lds_dwordx4 v9, s[64:65] offset:1024
    global_load_lds_dwordx4 v10, s[64:65] offset:2048
    global_load_lds_dwordx4 v11, s[64:65] offset:3072
    s_add_u32 s64, s64, 524288
    s_addc_u32 s65, s65, 0
    s_branch L_l_g2
L_end:
    s_endpgm
.section .rodata,"a"
.p2align 6
.amdhsa_kernel standalone__mixer_token_mlp__prompt_kernel
.amdhsa_next_free_vgpr 196
.amdhsa_next_free_sgpr 102
.amdhsa_accum_offset 196
.amdhsa_group_segment_fixed_size 0
.amdhsa_kernarg_size 64
.amdhsa_user_sgpr_count 2
.amdhsa_user_sgpr_kernarg_segment_ptr 1
.amdhsa_system_sgpr_workgroup_id_x 1
.end_amdhsa_kernel
```
